```python
import torch

def _softmax(x, axis=-1):
    return torch.softmax(x, dim=axis)
def _gelu(x):
    return torch.nn.functional.gelu(x, approximate="tanh")
def _silu(x):
    return torch.nn.functional.silu(x)
def _sigmoid(x):
    return torch.sigmoid(x)
def _layernorm(x, axis=-1, eps=1e-5):
    m = x.mean(dim=axis, keepdim=True)
    v = x.var(dim=axis, keepdim=True, unbiased=False)
    return (x - m) / torch.sqrt(v + eps)
def _scatter_add(tgt, idx, src, axis=0):
    return tgt.clone().index_add_(axis, idx, src)
def _segment_sum(src, seg, n):
    out = torch.zeros((n,) + src.shape[1:], dtype=src.dtype)
    return out.index_add_(0, seg, src)
def _pad(x, pw):
    flat = tuple(v for pair in reversed(pw) for v in pair)
    return torch.nn.functional.pad(x, flat)

kernel_name = 'concat_heads__gqa_block_cached__mha_block_cached__near_ridge'

def setup_inputs():

    _w = (lambda a: (lambda t: t.to(torch.bfloat16) if t.is_floating_point() else t)(torch.as_tensor(a)))
    def _A_setup():
        B, Sq, D = 8, 112, 576
        Hq, Hkv, Sk, Dh = 32, 16, 1024, 128
        assert Hq % Hkv == 0, (Hq, Hkv)
        return {
            "x": _w((lambda *s: torch.randn(*s, dtype=torch.bfloat16) * 0.8)(B, Sq, D)),
            "k_cache": _w((lambda *s: torch.randn(*s, dtype=torch.bfloat16) * 0.8)(B, Hkv, Sk, Dh)),
            "v_cache": _w((lambda *s: torch.randn(*s, dtype=torch.bfloat16) * 0.05)(B, Hkv, Sk, Dh)),
            "wq": _w((lambda *s: torch.randn(*s, dtype=torch.bfloat16) * 0.8)(D, Hq * Dh) * (D ** -0.5)),
            "wo": _w((lambda *s: torch.randn(*s, dtype=torch.bfloat16) * 0.05)(Hq * Dh, D) * ((Hq * Dh) ** -0.5)),
        }
    _A_in = _A_setup()

    def _B_setup():
        B, Sq, D = 8, 112, 576
        H, Sk, Dh = 32, 1024, 128
        return {
            "x": _w((lambda *s: torch.randn(*s, dtype=torch.bfloat16) * 0.8)(B, Sq, D)),
            "k_cache": _w((lambda *s: torch.randn(*s, dtype=torch.bfloat16) * 0.8)(B, H, Sk, Dh)),
            "v_cache": _w((lambda *s: torch.randn(*s, dtype=torch.bfloat16) * 0.05)(B, H, Sk, Dh)),
            "wq": _w((lambda *s: torch.randn(*s, dtype=torch.bfloat16) * 0.8)(D, H * Dh) * (D ** -0.5)),
            "wo": _w((lambda *s: torch.randn(*s, dtype=torch.bfloat16) * 0.05)(H * Dh, D) * ((H * Dh) ** -0.5)),
        }
    _B_in = _B_setup()

    return {
        "A_x": _A_in["x"],
        "A_k_cache": _A_in["k_cache"],
        "A_v_cache": _A_in["v_cache"],
        "A_wq": _A_in["wq"],
        "A_wo": _A_in["wo"],
        "B_x": _B_in["x"],
        "B_k_cache": _B_in["k_cache"],
        "B_v_cache": _B_in["v_cache"],
        "B_wq": _B_in["wq"],
        "B_wo": _B_in["wo"],
    }

def reference(A_x, A_k_cache, A_v_cache, A_wq, A_wo, B_x, B_k_cache, B_v_cache, B_wq, B_wo):
    def _A_ref(x, k_cache, v_cache, wq, wo):
        B, Sq, D = x.shape
        Hq, Dh = 32, 128
        Hkv = k_cache.shape[1]
        rep = Hq // Hkv
        q = (lambda x, *d: x.permute(*d))((x @ wq).reshape(B, Sq, Hq, Dh), 0, 2, 1, 3)
        k = (lambda x, n, axis: torch.repeat_interleave(x, n, dim=axis))(k_cache, rep, axis=1)
        v = (lambda x, n, axis: torch.repeat_interleave(x, n, dim=axis))(v_cache, rep, axis=1)
        scores = torch.einsum("bhqd,bhkd->bhqk", q, k) * (Dh ** -0.5)
        p = _softmax(scores, axis=-1)
        o = torch.einsum("bhqk,bhkd->bhqd", p, v)
        return (lambda x, *d: x.permute(*d))(o, 0, 2, 1, 3).reshape(B, Sq, Hq * Dh) @ wo

    def _B_ref(x, k_cache, v_cache, wq, wo):
        B, Sq, D = x.shape
        H, Dh = 32, 128
        q = (lambda x, *d: x.permute(*d))((x @ wq).reshape(B, Sq, H, Dh), 0, 2, 1, 3)
        scores = torch.einsum("bhqd,bhkd->bhqk", q, k_cache) * (Dh ** -0.5)
        p = _softmax(scores, axis=-1)
        o = torch.einsum("bhqk,bhkd->bhqd", p, v_cache)
        return (lambda x, *d: x.permute(*d))(o, 0, 2, 1, 3).reshape(B, Sq, H * Dh) @ wo

    a = _A_ref(A_x, A_k_cache, A_v_cache, A_wq, A_wo)
    b = _B_ref(B_x, B_k_cache, B_v_cache, B_wq, B_wo)
    return torch.concatenate([a, b], axis=-1)
```

```asm
; @launch grid=(256,1,1) block=(256,1,1) lds=163840
.amdgcn_target "amdgcn-amd-amdhsa--gfx950"
.text
.p2align 8
.globl concat_heads__gqa_block_cached__mha_block_cached__near_ridge_kernel
.type concat_heads__gqa_block_cached__mha_block_cached__near_ridge_kernel,@function
concat_heads__gqa_block_cached__mha_block_cached__near_ridge_kernel:
s_cmp_ge_u32 s2, 256
s_cbranch_scc1 L1_end
s_load_dwordx16 s[28:43], s[0:1], 0
s_load_dwordx4 s[44:47], s[0:1], 64
s_load_dwordx2 s[20:21], s[0:1], 96
v_lshrrev_b32 v1, 6, v0
v_and_b32 v0, 63, v0
v_readfirstlane_b32 s24, v1
v_lshlrev_b32 v250, 4, v0
s_lshr_b32 s3, s2, 3
s_and_b32 s25, s3, 1
s_and_b32 s26, s2, 7
s_lshl_b32 s26, s26, 1
s_bfe_u32 s27, s3, 0x10001
s_add_u32 s26, s26, s27
s_lshr_b32 s27, s3, 2
s_and_b32 s48, s24, 1
s_lshr_b32 s49, s24, 1
s_lshl_b32 s50, s24, 15
v_and_b32 v1, 15, v0
v_lshrrev_b32 v2, 4, v0
v_lshrrev_b32 v3, 3, v0
v_and_b32 v4, 7, v0
v_and_b32 v5, 1, v2
v_lshlrev_b32 v5, 2, v5
v_xor_b32 v5, v5, v4
v_lshlrev_b32 v5, 4, v5
v_lshl_add_u32 v186, v3, 13, v5
v_add_u32 v187, 64512, v186
v_add_u32 v188, 129024, v186
v_add_u32 v189, 193536, v186
s_lshl_b32 s51, s24, 5
v_add_u32 v5, s51, v3
v_mul_u32_u24 v5, 1152, v5
v_xor_b32 v6, 0, v2
v_xor_b32 v6, v6, v4
v_lshl_add_u32 v6, v6, 4, v5
v_add_u32 v182, 0, v6
v_xor_b32 v6, 4, v2
v_xor_b32 v6, v6, v4
v_lshl_add_u32 v6, v6, 4, v5
v_add_u32 v183, 8192, v6
v_xor_b32 v6, 0, v2
v_xor_b32 v6, v6, v4
v_lshl_add_u32 v6, v6, 4, v5
v_add_u32 v184, 16384, v6
v_xor_b32 v6, 4, v2
v_xor_b32 v6, v6, v4
v_lshl_add_u32 v6, v6, 4, v5
v_add_u32 v185, 24576, v6
s_mul_i32 s53, s27, 129024
s_lshl_b32 s54, s26, 9
s_lshl_b32 s51, s24, 7
s_add_u32 s54, s54, s51
s_lshl_b32 s55, s24, 12
s_add_u32 s55, s55, 131072
s_and_b32 s52, s2, 7
s_add_u32 s52, s52, s27
s_and_b32 s51, s26, 1
s_lshl_b32 s51, s51, 2
s_add_u32 s52, s52, s51
s_mul_i32 s51, s52, 7282
s_lshr_b32 s51, s51, 16
s_mul_i32 s51, s51, 9
s_sub_u32 s52, s52, s51
s_lshl_b32 s56, s52, 7
s_add_u32 s56, s56, s53
s_lshl_b32 s57, s52, 19
s_add_u32 s57, s57, s54
s_mov_b32 s6, 1032192
s_mov_b32 s10, 4718592
s_mov_b32 s14, 131072
s_mov_b32 s18, 131072
s_mov_b32 s22, 33816576
s_mov_b32 s94, 294912
s_mov_b32 s7, 0x20000
s_mov_b32 s11, 0x20000
s_mov_b32 s15, 0x20000
s_mov_b32 s19, 0x20000
s_mov_b32 s23, 0x20000
s_mov_b32 s95, 0x20000
s_mul_i32 s97, s24, 73728
s_add_u32 s98, s97, 1152
s_lshl_b32 s96, s27, 7
s_add_u32 s96, s96, s97
s_lshl_b32 s51, s27, 4
s_add_u32 s51, s51, s26
s_lshl_b32 s52, s51, 1
s_add_u32 s52, s52, s49
s_cmp_eq_u32 s25, 1
s_cselect_b32 s51, s52, s51
s_lshl_b32 s51, s51, 1
s_add_u32 s51, s51, s48
s_lshl_b32 s51, s51, 17
s_mul_i32 s52, s26, 294912
s_cmp_eq_u32 s25, 1
s_waitcnt lgkmcnt(0)
s_cselect_b32 s8, s44, s34
s_cselect_b32 s9, s45, s35
s_cselect_b32 s4, s38, s28
s_cselect_b32 s5, s39, s29
s_cselect_b32 s12, s40, s30
s_cselect_b32 s13, s41, s31
s_cselect_b32 s16, s42, s32
s_cselect_b32 s17, s43, s33
s_cselect_b32 s92, s46, s36
s_cselect_b32 s93, s47, s37
s_mov_b32 s31, s57
s_add_u32 s36, s50, 24576
s_mov_b32 s30, s56
s_add_u32 s34, s53, 1152
s_add_u32 s35, s54, 4718592
s_mov_b32 m0, s36
s_nop 0
buffer_load_dwordx4 v186, s[8:11], s31 offen offset:0  lds
buffer_load_dwordx4 v187, s[8:11], s31 offen offset:1024  lds
buffer_load_dwordx4 v188, s[8:11], s31 offen offset:2048  lds
buffer_load_dwordx4 v189, s[8:11], s31 offen offset:3072  lds
s_mov_b32 m0, s55
s_xor_b32 s55, s55, 16384
buffer_load_dwordx4 v182, s[4:7], s30 offen offset:0  lds
buffer_load_dwordx4 v183, s[4:7], s30 offen offset:1024  lds
buffer_load_dwordx4 v184, s[4:7], s30 offen offset:2048  lds
buffer_load_dwordx4 v185, s[4:7], s30 offen offset:3072  lds
s_add_u32 m0, s36, 4096
s_add_u32 s31, s31, 262144
s_cmp_eq_u32 s31, s35
s_cselect_b32 s31, s54, s31
buffer_load_dwordx4 v186, s[8:11], s31 offen offset:0  lds
buffer_load_dwordx4 v187, s[8:11], s31 offen offset:1024  lds
buffer_load_dwordx4 v188, s[8:11], s31 offen offset:2048  lds
buffer_load_dwordx4 v189, s[8:11], s31 offen offset:3072  lds
s_xor_b32 m0, s36, 8192
s_add_u32 s31, s31, 262144
s_cmp_eq_u32 s31, s35
s_cselect_b32 s31, s54, s31
buffer_load_dwordx4 v186, s[8:11], s31 offen offset:0  lds
buffer_load_dwordx4 v187, s[8:11], s31 offen offset:1024  lds
buffer_load_dwordx4 v188, s[8:11], s31 offen offset:2048  lds
buffer_load_dwordx4 v189, s[8:11], s31 offen offset:3072  lds
s_add_u32 s31, s31, 262144
s_cmp_eq_u32 s31, s35
s_cselect_b32 s31, s54, s31
s_add_u32 s30, s30, 128
s_cmp_eq_u32 s30, s34
s_cselect_b32 s30, s53, s30
s_add_u32 s12, s12, s51
s_addc_u32 s13, s13, 0
s_add_u32 s16, s16, s51
s_addc_u32 s17, s17, 0
s_add_u32 s92, s92, s52
s_addc_u32 s93, s93, 0
v_lshlrev_b32 v5, 8, v2
v_or_b32 v6, 0, v2
v_xor_b32 v6, v6, v1
v_lshl_add_u32 v244, v6, 4, v5
v_or_b32 v6, 4, v2
v_xor_b32 v6, v6, v1
v_lshl_add_u32 v245, v6, 4, v5
v_or_b32 v6, 8, v2
v_xor_b32 v6, v6, v1
v_lshl_add_u32 v246, v6, 4, v5
v_or_b32 v6, 12, v2
v_xor_b32 v6, v6, v1
v_lshl_add_u32 v247, v6, 4, v5
v_or_b32 v6, 0, v2
v_lshlrev_b32 v6, 1, v6
v_xor_b32 v6, v6, v1
v_lshl_add_u32 v248, v6, 4, v5
v_or_b32 v6, 4, v2
v_lshlrev_b32 v6, 1, v6
v_xor_b32 v6, v6, v1
v_lshl_add_u32 v249, v6, 4, v5
s_mov_b32 s33, 0
s_mov_b32 s32, s25
s_mul_i32 s32, s32, 1
s_add_u32 s33, s33, s32
s_mov_b32 s32, s27
s_mul_i32 s32, s32, 4
s_add_u32 s33, s33, s32
s_mov_b32 s32, s48
s_mul_i32 s32, s32, 2
s_add_u32 s33, s33, s32
s_and_b32 s33, s33, 31
s_lshl_b32 s33, s33, 12
v_lshlrev_b32 v5, 1, v2
v_xor_b32 v5, v5, v4
v_mul_u32_u24 v6, 1152, v3
v_lshl_add_u32 v255, v5, 4, v6
s_lshl_b32 s99, s24, 13
s_add_u32 s99, s99, 131072
s_xor_b32 s100, s50, 32768
s_mov_b32 s56, 0
v_lshrrev_b32 v5, 1, v1
v_lshlrev_b32 v7, 7, v1
v_add_u32 v7, 131072, v7
v_or_b32 v6, 0, v2
v_xor_b32 v6, v6, v5
v_lshl_add_u32 v176, v6, 4, v7
v_or_b32 v6, 4, v2
v_xor_b32 v6, v6, v5
v_lshl_add_u32 v177, v6, 4, v7
v_lshrrev_b32 v8, 2, v1
v_and_b32 v9, 3, v0
v_lshl_add_u32 v5, v2, 3, v8
v_lshlrev_b32 v5, 7, v5
v_add_u32 v5, s36, v5
v_lshrrev_b32 v6, 1, v8
v_lshlrev_b32 v6, 2, v6
v_xor_b32 v6, v6, v9
v_xor_b32 v7, 0, v6
v_lshl_add_u32 v178, v7, 4, v5
v_xor_b32 v7, 4, v6
v_lshl_add_u32 v179, v7, 4, v5
v_lshlrev_b32 v5, 8, v1
v_add_u32 v5, s50, v5
s_lshl_b32 s51, s48, 3
v_xor_b32 v6, v2, v1
v_xor_b32 v6, s51, v6
v_xor_b32 v7, 0, v6
v_lshl_add_u32 v232, v7, 4, v5
v_xor_b32 v7, 4, v6
v_lshl_add_u32 v233, v7, 4, v5
v_xor_b32 v7, 8, v6
v_lshl_add_u32 v234, v7, 4, v5
v_xor_b32 v7, 12, v6
v_lshl_add_u32 v235, v7, 4, v5
v_lshl_add_u32 v5, v2, 2, v8
v_and_b32 v6, 7, v5
v_lshlrev_b32 v6, 1, v6
v_lshrrev_b32 v7, 1, v9
v_xor_b32 v6, v6, v7
v_xor_b32 v6, s51, v6
v_lshlrev_b32 v5, 8, v5
v_and_b32 v7, 1, v9
v_lshl_add_u32 v5, v7, 3, v5
v_add_u32 v5, s50, v5
v_add_u32 v5, 8192, v5
v_xor_b32 v7, 0, v6
v_lshl_add_u32 v236, v7, 4, v5
v_xor_b32 v7, 2, v6
v_lshl_add_u32 v237, v7, 4, v5
v_xor_b32 v7, 4, v6
v_lshl_add_u32 v238, v7, 4, v5
v_xor_b32 v7, 6, v6
v_lshl_add_u32 v239, v7, 4, v5
v_xor_b32 v7, 8, v6
v_lshl_add_u32 v240, v7, 4, v5
v_xor_b32 v7, 10, v6
v_lshl_add_u32 v241, v7, 4, v5
v_xor_b32 v7, 12, v6
v_lshl_add_u32 v242, v7, 4, v5
v_xor_b32 v7, 14, v6
v_lshl_add_u32 v243, v7, 4, v5
v_mov_b32 v228, 0x3f803f80
v_mov_b32 v229, 0x3f803f80
v_mov_b32 v230, 0x3f803f80
v_mov_b32 v231, 0x3f803f80
v_mov_b32 v200, 0
v_mov_b32 v201, 0
v_mov_b32 v202, 0
v_mov_b32 v203, 0
v_mov_b32 v204, 0
v_mov_b32 v205, 0
v_mov_b32 v206, 0
v_mov_b32 v207, 0
v_mov_b32 v208, 0
v_mov_b32 v209, 0
v_mov_b32 v210, 0
v_mov_b32 v211, 0
v_mov_b32 v212, 0
v_mov_b32 v213, 0
v_mov_b32 v214, 0
v_mov_b32 v215, 0
v_mov_b32 v216, 0
v_mov_b32 v217, 0
v_mov_b32 v218, 0
v_mov_b32 v219, 0
v_mov_b32 v220, 0
v_mov_b32 v221, 0
v_mov_b32 v222, 0
v_mov_b32 v223, 0
v_mov_b32 v224, 0
v_mov_b32 v225, 0
v_mov_b32 v226, 0
v_mov_b32 v227, 0
s_mov_b32 s57, 0
v_mov_b32 v192, 0
v_mov_b32 v193, 0
v_mov_b32 v194, 0
v_mov_b32 v195, 0
v_mov_b32 v196, 0
v_mov_b32 v197, 0
v_mov_b32 v198, 0
v_mov_b32 v199, 0
s_mov_b32 s37, 0
s_bfe_u32 s38, s2, 0x30003
s_min_u32 s38, s38, 6
v_mfma_f32_32x32x16_bf16 v[128:143], v[192:195], v[192:195], 0
v_mfma_f32_32x32x16_bf16 a[128:143], v[192:195], v[192:195], 0
v_mfma_f32_32x32x16_bf16 a[144:159], v[192:195], v[192:195], 0
v_mfma_f32_32x32x16_bf16 a[160:175], v[192:195], v[192:195], 0
v_mfma_f32_32x32x16_bf16 v[0:15], v[192:195], v[192:195], 0
v_mfma_f32_32x32x16_bf16 v[16:31], v[192:195], v[192:195], 0
v_mfma_f32_32x32x16_bf16 v[32:47], v[192:195], v[192:195], 0
v_mfma_f32_32x32x16_bf16 v[48:63], v[192:195], v[192:195], 0
v_mfma_f32_32x32x16_bf16 v[64:79], v[192:195], v[192:195], 0
v_mfma_f32_32x32x16_bf16 v[80:95], v[192:195], v[192:195], 0
v_mfma_f32_32x32x16_bf16 v[96:111], v[192:195], v[192:195], 0
v_mfma_f32_32x32x16_bf16 v[144:159], v[192:195], v[192:195], 0
v_mfma_f32_32x32x16_bf16 v[160:175], v[192:195], v[192:195], 0
v_mfma_f32_32x32x16_bf16 a[176:191], v[192:195], v[192:195], 0
v_mfma_f32_32x32x16_bf16 a[192:207], v[192:195], v[192:195], 0
v_mfma_f32_32x32x16_bf16 a[208:223], v[192:195], v[192:195], 0
v_mfma_f32_32x32x16_bf16 a[224:239], v[192:195], v[192:195], 0
v_mfma_f32_16x16x32_bf16 a[240:243], v[192:195], v[192:195], 0
v_mfma_f32_16x16x32_bf16 a[244:247], v[192:195], v[192:195], 0
v_mfma_f32_16x16x32_bf16 a[248:251], v[192:195], v[192:195], 0
v_lshrrev_b32 v112, 6, v250
v_bfe_u32 v113, v250, 5, 1
s_lshl_b32 s51, s24, 1
v_or_b32 v113, s51, v113
v_and_b32 v114, 6, v112
v_xor_b32 v113, v113, v114
v_lshlrev_b32 v113, 4, v113
v_lshl_add_u32 v113, v112, 7, v113
v_bfe_u32 v114, v250, 4, 1
v_lshl_add_u32 v113, v114, 3, v113
v_add_u32 v112, s100, v113
v_add_u32 v113, s99, v113
v_accvgpr_write_b32 a252, v112
v_accvgpr_write_b32 a253, v113
s_lshl_b32 s39, s25, 3
s_add_u32 s39, s39, s27
s_lshl_b32 s39, s39, 4
s_add_u32 s39, s39, s26
s_lshl_b32 s101, s39, 10
s_add_u32 s101, s101, 33554432
s_lshl_b32 s39, s39, 17
s_add_u32 s39, s39, s50
s_xor_b32 s51, s50, 32768
v_add_u32 v251, s51, v250
v_add_u32 v252, s50, v250
s_xor_b32 s51, s99, 8192
v_add_u32 v253, s51, v250
v_add_u32 v254, s99, v250
s_mov_b32 s58, 0x3e0293ee
s_mov_b32 s59, 0x3e0293ee
.p2align 6
L1_qp:
s_waitcnt vmcnt(8) lgkmcnt(0)
s_barrier
s_cmp_lg_u32 s37, s38
s_cbranch_scc1 L1_nokv
s_add_u32 m0, s50, 0
s_add_u32 s51, s56, 0
s_xor_b32 s51, s51, s33
buffer_load_dwordx4 v244, s[12:15], s51 offen offset:0 nt lds
buffer_load_dwordx4 v245, s[12:15], s51 offen offset:1024 nt lds
buffer_load_dwordx4 v246, s[12:15], s51 offen offset:2048 nt lds
buffer_load_dwordx4 v247, s[12:15], s51 offen offset:3072 nt lds
s_add_u32 m0, s50, 4096
s_add_u32 s51, s56, 4096
s_xor_b32 s51, s51, s33
buffer_load_dwordx4 v244, s[12:15], s51 offen offset:0 nt lds
buffer_load_dwordx4 v245, s[12:15], s51 offen offset:1024 nt lds
buffer_load_dwordx4 v246, s[12:15], s51 offen offset:2048 nt lds
buffer_load_dwordx4 v247, s[12:15], s51 offen offset:3072 nt lds
s_add_u32 m0, s50, 8192
s_add_u32 s51, s56, 0
s_xor_b32 s51, s51, s33
buffer_load_dwordx4 v248, s[16:19], s51 offen offset:0 nt lds
buffer_load_dwordx4 v249, s[16:19], s51 offen offset:1024 nt lds
buffer_load_dwordx4 v248, s[16:19], s51 offen offset:2048 nt lds
buffer_load_dwordx4 v249, s[16:19], s51 offen offset:3072 nt lds
s_add_u32 m0, s50, 12288
s_add_u32 s51, s56, 4096
s_xor_b32 s51, s51, s33
buffer_load_dwordx4 v248, s[16:19], s51 offen offset:0 nt lds
buffer_load_dwordx4 v249, s[16:19], s51 offen offset:1024 nt lds
buffer_load_dwordx4 v248, s[16:19], s51 offen offset:2048 nt lds
buffer_load_dwordx4 v249, s[16:19], s51 offen offset:3072 nt lds
L1_nokv:
v_mfma_f32_16x16x32_bf16 v[0:3], v[128:131], a[140:143], v[0:3]
ds_read_b64_tr_b16 v[112:113], v178 offset:0
v_mfma_f32_16x16x32_bf16 v[4:7], v[132:135], a[140:143], v[4:7]
ds_read_b64_tr_b16 v[114:115], v178 offset:512
s_mov_b32 m0, s55
v_mfma_f32_16x16x32_bf16 v[8:11], v[136:139], a[140:143], v[8:11]
ds_read_b64_tr_b16 v[116:117], v178 offset:8
s_xor_b32 s55, s55, 16384
v_mfma_f32_16x16x32_bf16 v[12:15], v[140:143], a[140:143], v[12:15]
buffer_load_dwordx4 v182, s[4:7], s30 offen offset:0  lds
v_mfma_f32_16x16x32_bf16 v[16:19], v[128:131], a[144:147], v[16:19]
ds_read_b64_tr_b16 v[118:119], v178 offset:520
v_mfma_f32_16x16x32_bf16 v[20:23], v[132:135], a[144:147], v[20:23]
ds_read_b64_tr_b16 v[120:121], v179 offset:0
v_mfma_f32_16x16x32_bf16 v[24:27], v[136:139], a[144:147], v[24:27]
ds_read_b64_tr_b16 v[122:123], v179 offset:512
v_mfma_f32_16x16x32_bf16 v[28:31], v[140:143], a[144:147], v[28:31]
buffer_load_dwordx4 v183, s[4:7], s30 offen offset:1024  lds
v_mfma_f32_16x16x32_bf16 v[32:35], v[128:131], a[148:151], v[32:35]
ds_read_b64_tr_b16 v[124:125], v179 offset:8
v_mfma_f32_16x16x32_bf16 v[36:39], v[132:135], a[148:151], v[36:39]
ds_read_b64_tr_b16 v[126:127], v179 offset:520
v_mfma_f32_16x16x32_bf16 v[40:43], v[136:139], a[148:151], v[40:43]
ds_read_b128 a[112:115], v176 offset:0
v_mfma_f32_16x16x32_bf16 v[44:47], v[140:143], a[148:151], v[44:47]
buffer_load_dwordx4 v184, s[4:7], s30 offen offset:2048  lds
v_mfma_f32_16x16x32_bf16 v[48:51], v[128:131], a[152:155], v[48:51]
ds_read_b128 a[116:119], v176 offset:2048
v_mfma_f32_16x16x32_bf16 v[52:55], v[132:135], a[152:155], v[52:55]
ds_read_b128 a[120:123], v176 offset:4096
v_mfma_f32_16x16x32_bf16 v[56:59], v[136:139], a[152:155], v[56:59]
ds_read_b128 a[124:127], v176 offset:6144
v_mfma_f32_16x16x32_bf16 v[60:63], v[140:143], a[152:155], v[60:63]
buffer_load_dwordx4 v185, s[4:7], s30 offen offset:3072  lds
v_mfma_f32_16x16x32_bf16 v[64:67], v[128:131], a[156:159], v[64:67]
ds_read_b128 a[128:131], v176 offset:8192
s_xor_b32 s36, s36, 8192
v_mfma_f32_16x16x32_bf16 v[68:71], v[132:135], a[156:159], v[68:71]
ds_read_b128 a[132:135], v176 offset:10240
s_add_u32 m0, s36, 4096
v_mfma_f32_16x16x32_bf16 v[72:75], v[136:139], a[156:159], v[72:75]
ds_read_b128 a[136:139], v176 offset:12288
v_mfma_f32_16x16x32_bf16 v[76:79], v[140:143], a[156:159], v[76:79]
buffer_load_dwordx4 v186, s[8:11], s31 offen offset:0  lds
v_mfma_f32_16x16x32_bf16 v[80:83], v[128:131], a[160:163], v[80:83]
s_add_u32 s30, s30, 128
v_mfma_f32_16x16x32_bf16 v[84:87], v[132:135], a[160:163], v[84:87]
s_cmp_eq_u32 s30, s34
s_cselect_b32 s30, s53, s30
v_mfma_f32_16x16x32_bf16 v[88:91], v[136:139], a[160:163], v[88:91]
v_mfma_f32_16x16x32_bf16 v[92:95], v[140:143], a[160:163], v[92:95]
buffer_load_dwordx4 v187, s[8:11], s31 offen offset:1024  lds
v_mfma_f32_16x16x32_bf16 v[96:99], v[128:131], a[164:167], v[96:99]
v_mfma_f32_16x16x32_bf16 v[100:103], v[132:135], a[164:167], v[100:103]
v_mfma_f32_16x16x32_bf16 v[104:107], v[136:139], a[164:167], v[104:107]
v_mfma_f32_16x16x32_bf16 v[108:111], v[140:143], a[164:167], v[108:111]
s_waitcnt vmcnt(10) lgkmcnt(0)
v_mfma_f32_16x16x32_bf16 v[0:3], v[112:115], a[112:115], v[0:3]
ds_read_b64_tr_b16 v[128:129], v178 offset:4096
v_mfma_f32_16x16x32_bf16 v[4:7], v[116:119], a[112:115], v[4:7]
ds_read_b64_tr_b16 v[130:131], v178 offset:4608
v_mfma_f32_16x16x32_bf16 v[8:11], v[120:123], a[112:115], v[8:11]
ds_read_b64_tr_b16 v[132:133], v178 offset:4104
v_mfma_f32_16x16x32_bf16 v[12:15], v[124:127], a[112:115], v[12:15]
buffer_load_dwordx4 v188, s[8:11], s31 offen offset:2048  lds
v_mfma_f32_16x16x32_bf16 v[16:19], v[112:115], a[116:119], v[16:19]
ds_read_b64_tr_b16 v[134:135], v178 offset:4616
v_mfma_f32_16x16x32_bf16 v[20:23], v[116:119], a[116:119], v[20:23]
ds_read_b64_tr_b16 v[136:137], v179 offset:4096
v_mfma_f32_16x16x32_bf16 v[24:27], v[120:123], a[116:119], v[24:27]
ds_read_b64_tr_b16 v[138:139], v179 offset:4608
v_mfma_f32_16x16x32_bf16 v[28:31], v[124:127], a[116:119], v[28:31]
buffer_load_dwordx4 v189, s[8:11], s31 offen offset:3072  lds
v_mfma_f32_16x16x32_bf16 v[32:35], v[112:115], a[120:123], v[32:35]
ds_read_b64_tr_b16 v[140:141], v179 offset:4104
s_add_u32 s31, s31, 262144
v_mfma_f32_16x16x32_bf16 v[36:39], v[116:119], a[120:123], v[36:39]
ds_read_b64_tr_b16 v[142:143], v179 offset:4616
s_cmp_eq_u32 s31, s35
s_cselect_b32 s31, s54, s31
v_mfma_f32_16x16x32_bf16 v[40:43], v[120:123], a[120:123], v[40:43]
ds_read_b128 a[140:143], v177 offset:0
s_xor_b32 m0, s36, 8192
v_mfma_f32_16x16x32_bf16 v[44:47], v[124:127], a[120:123], v[44:47]
buffer_load_dwordx4 v186, s[8:11], s31 offen offset:0  lds
v_mfma_f32_16x16x32_bf16 v[48:51], v[112:115], a[124:127], v[48:51]
ds_read_b128 a[144:147], v177 offset:2048
v_mfma_f32_16x16x32_bf16 v[52:55], v[116:119], a[124:127], v[52:55]
ds_read_b128 a[148:151], v177 offset:4096
v_mfma_f32_16x16x32_bf16 v[56:59], v[120:123], a[124:127], v[56:59]
ds_read_b128 a[152:155], v177 offset:6144
v_mfma_f32_16x16x32_bf16 v[60:63], v[124:127], a[124:127], v[60:63]
buffer_load_dwordx4 v187, s[8:11], s31 offen offset:1024  lds
v_mfma_f32_16x16x32_bf16 v[64:67], v[112:115], a[128:131], v[64:67]
ds_read_b128 a[156:159], v177 offset:8192
v_mfma_f32_16x16x32_bf16 v[68:71], v[116:119], a[128:131], v[68:71]
ds_read_b128 a[160:163], v177 offset:10240
v_mfma_f32_16x16x32_bf16 v[72:75], v[120:123], a[128:131], v[72:75]
ds_read_b128 a[164:167], v177 offset:12288
v_mfma_f32_16x16x32_bf16 v[76:79], v[124:127], a[128:131], v[76:79]
buffer_load_dwordx4 v188, s[8:11], s31 offen offset:2048  lds
v_mfma_f32_16x16x32_bf16 v[80:83], v[112:115], a[132:135], v[80:83]
v_xor_b32 v176, 16384, v176
v_xor_b32 v177, 16384, v177
v_mfma_f32_16x16x32_bf16 v[84:87], v[116:119], a[132:135], v[84:87]
v_mfma_f32_16x16x32_bf16 v[88:91], v[120:123], a[132:135], v[88:91]
v_xor_b32 v178, 8192, v178
v_xor_b32 v179, 8192, v179
v_mfma_f32_16x16x32_bf16 v[92:95], v[124:127], a[132:135], v[92:95]
buffer_load_dwordx4 v189, s[8:11], s31 offen offset:3072  lds
v_mfma_f32_16x16x32_bf16 v[96:99], v[112:115], a[136:139], v[96:99]
s_add_u32 s31, s31, 262144
v_mfma_f32_16x16x32_bf16 v[100:103], v[116:119], a[136:139], v[100:103]
s_cmp_eq_u32 s31, s35
s_cselect_b32 s31, s54, s31
v_mfma_f32_16x16x32_bf16 v[104:107], v[120:123], a[136:139], v[104:107]
s_add_u32 s37, s37, 1
v_mfma_f32_16x16x32_bf16 v[108:111], v[124:127], a[136:139], v[108:111]
s_cmp_lt_u32 s37, 7
s_cbranch_scc1 L1_qp
s_waitcnt vmcnt(8) lgkmcnt(0)
s_barrier
v_mfma_f32_16x16x32_bf16 v[0:3], v[128:131], a[140:143], v[0:3]
ds_read_b64_tr_b16 v[112:113], v178 offset:0
v_mfma_f32_16x16x32_bf16 v[4:7], v[132:135], a[140:143], v[4:7]
ds_read_b64_tr_b16 v[114:115], v178 offset:512
s_mov_b32 m0, s55
v_mfma_f32_16x16x32_bf16 v[8:11], v[136:139], a[140:143], v[8:11]
ds_read_b64_tr_b16 v[116:117], v178 offset:8
s_xor_b32 s55, s55, 16384
v_mfma_f32_16x16x32_bf16 v[12:15], v[140:143], a[140:143], v[12:15]
buffer_load_dwordx4 v182, s[4:7], s30 offen offset:0  lds
v_mfma_f32_16x16x32_bf16 v[16:19], v[128:131], a[144:147], v[16:19]
ds_read_b64_tr_b16 v[118:119], v178 offset:520
v_mfma_f32_16x16x32_bf16 v[20:23], v[132:135], a[144:147], v[20:23]
ds_read_b64_tr_b16 v[120:121], v179 offset:0
v_mfma_f32_16x16x32_bf16 v[24:27], v[136:139], a[144:147], v[24:27]
ds_read_b64_tr_b16 v[122:123], v179 offset:512
v_mfma_f32_16x16x32_bf16 v[28:31], v[140:143], a[144:147], v[28:31]
buffer_load_dwordx4 v183, s[4:7], s30 offen offset:1024  lds
v_mfma_f32_16x16x32_bf16 v[32:35], v[128:131], a[148:151], v[32:35]
ds_read_b64_tr_b16 v[124:125], v179 offset:8
v_mfma_f32_16x16x32_bf16 v[36:39], v[132:135], a[148:151], v[36:39]
ds_read_b64_tr_b16 v[126:127], v179 offset:520
v_mfma_f32_16x16x32_bf16 v[40:43], v[136:139], a[148:151], v[40:43]
ds_read_b128 a[112:115], v176 offset:0
v_mfma_f32_16x16x32_bf16 v[44:47], v[140:143], a[148:151], v[44:47]
buffer_load_dwordx4 v184, s[4:7], s30 offen offset:2048  lds
v_mfma_f32_16x16x32_bf16 v[48:51], v[128:131], a[152:155], v[48:51]
ds_read_b128 a[116:119], v176 offset:2048
v_mfma_f32_16x16x32_bf16 v[52:55], v[132:135], a[152:155], v[52:55]
ds_read_b128 a[120:123], v176 offset:4096
v_mfma_f32_16x16x32_bf16 v[56:59], v[136:139], a[152:155], v[56:59]
ds_read_b128 a[124:127], v176 offset:6144
v_mfma_f32_16x16x32_bf16 v[60:63], v[140:143], a[152:155], v[60:63]
buffer_load_dwordx4 v185, s[4:7], s30 offen offset:3072  lds
v_mfma_f32_16x16x32_bf16 v[64:67], v[128:131], a[156:159], v[64:67]
ds_read_b128 a[128:131], v176 offset:8192
s_xor_b32 s36, s36, 8192
v_mfma_f32_16x16x32_bf16 v[68:71], v[132:135], a[156:159], v[68:71]
ds_read_b128 a[132:135], v176 offset:10240
s_add_u32 m0, s36, 4096
v_mfma_f32_16x16x32_bf16 v[72:75], v[136:139], a[156:159], v[72:75]
ds_read_b128 a[136:139], v176 offset:12288
v_mfma_f32_16x16x32_bf16 v[76:79], v[140:143], a[156:159], v[76:79]
buffer_load_dwordx4 v186, s[8:11], s31 offen offset:0  lds
v_mfma_f32_16x16x32_bf16 v[80:83], v[128:131], a[160:163], v[80:83]
s_add_u32 s30, s30, 128
v_mfma_f32_16x16x32_bf16 v[84:87], v[132:135], a[160:163], v[84:87]
s_cmp_eq_u32 s30, s34
s_cselect_b32 s30, s53, s30
v_mfma_f32_16x16x32_bf16 v[88:91], v[136:139], a[160:163], v[88:91]
v_mfma_f32_16x16x32_bf16 v[92:95], v[140:143], a[160:163], v[92:95]
buffer_load_dwordx4 v187, s[8:11], s31 offen offset:1024  lds
v_mfma_f32_16x16x32_bf16 v[96:99], v[128:131], a[164:167], v[96:99]
v_mfma_f32_16x16x32_bf16 v[100:103], v[132:135], a[164:167], v[100:103]
v_mfma_f32_16x16x32_bf16 v[104:107], v[136:139], a[164:167], v[104:107]
v_mfma_f32_16x16x32_bf16 v[108:111], v[140:143], a[164:167], v[108:111]
s_waitcnt vmcnt(10) lgkmcnt(0)
v_mfma_f32_16x16x32_bf16 v[0:3], v[112:115], a[112:115], v[0:3]
ds_read_b64_tr_b16 v[128:129], v178 offset:4096
v_mfma_f32_16x16x32_bf16 v[4:7], v[116:119], a[112:115], v[4:7]
ds_read_b64_tr_b16 v[130:131], v178 offset:4608
v_mfma_f32_16x16x32_bf16 v[8:11], v[120:123], a[112:115], v[8:11]
ds_read_b64_tr_b16 v[132:133], v178 offset:4104
v_mfma_f32_16x16x32_bf16 v[12:15], v[124:127], a[112:115], v[12:15]
buffer_load_dwordx4 v188, s[8:11], s31 offen offset:2048  lds
v_mfma_f32_16x16x32_bf16 v[16:19], v[112:115], a[116:119], v[16:19]
ds_read_b64_tr_b16 v[134:135], v178 offset:4616
v_mfma_f32_16x16x32_bf16 v[20:23], v[116:119], a[116:119], v[20:23]
ds_read_b64_tr_b16 v[136:137], v179 offset:4096
v_mfma_f32_16x16x32_bf16 v[24:27], v[120:123], a[116:119], v[24:27]
ds_read_b64_tr_b16 v[138:139], v179 offset:4608
v_mfma_f32_16x16x32_bf16 v[28:31], v[124:127], a[116:119], v[28:31]
buffer_load_dwordx4 v189, s[8:11], s31 offen offset:3072  lds
v_mfma_f32_16x16x32_bf16 v[32:35], v[112:115], a[120:123], v[32:35]
ds_read_b64_tr_b16 v[140:141], v179 offset:4104
v_mfma_f32_16x16x32_bf16 v[36:39], v[116:119], a[120:123], v[36:39]
ds_read_b64_tr_b16 v[142:143], v179 offset:4616
s_add_u32 m0, s50, 16384
v_mfma_f32_16x16x32_bf16 v[40:43], v[120:123], a[120:123], v[40:43]
ds_read_b128 a[140:143], v177 offset:0
s_add_u32 s51, s56, 8192
s_xor_b32 s51, s51, s33
v_mfma_f32_16x16x32_bf16 v[44:47], v[124:127], a[120:123], v[44:47]
buffer_load_dwordx4 v244, s[12:15], s51 offen offset:0 nt lds
v_mfma_f32_16x16x32_bf16 v[48:51], v[112:115], a[124:127], v[48:51]
ds_read_b128 a[144:147], v177 offset:2048
v_mfma_f32_16x16x32_bf16 v[52:55], v[116:119], a[124:127], v[52:55]
ds_read_b128 a[148:151], v177 offset:4096
v_mfma_f32_16x16x32_bf16 v[56:59], v[120:123], a[124:127], v[56:59]
ds_read_b128 a[152:155], v177 offset:6144
v_mfma_f32_16x16x32_bf16 v[60:63], v[124:127], a[124:127], v[60:63]
buffer_load_dwordx4 v245, s[12:15], s51 offen offset:1024 nt lds
v_mfma_f32_16x16x32_bf16 v[64:67], v[112:115], a[128:131], v[64:67]
ds_read_b128 a[156:159], v177 offset:8192
v_mfma_f32_16x16x32_bf16 v[68:71], v[116:119], a[128:131], v[68:71]
ds_read_b128 a[160:163], v177 offset:10240
v_mfma_f32_16x16x32_bf16 v[72:75], v[120:123], a[128:131], v[72:75]
ds_read_b128 a[164:167], v177 offset:12288
v_mfma_f32_16x16x32_bf16 v[76:79], v[124:127], a[128:131], v[76:79]
buffer_load_dwordx4 v246, s[12:15], s51 offen offset:2048 nt lds
v_mfma_f32_16x16x32_bf16 v[80:83], v[112:115], a[132:135], v[80:83]
v_xor_b32 v176, 16384, v176
v_xor_b32 v177, 16384, v177
v_mfma_f32_16x16x32_bf16 v[84:87], v[116:119], a[132:135], v[84:87]
v_mfma_f32_16x16x32_bf16 v[88:91], v[120:123], a[132:135], v[88:91]
v_xor_b32 v178, 8192, v178
v_xor_b32 v179, 8192, v179
v_mfma_f32_16x16x32_bf16 v[92:95], v[124:127], a[132:135], v[92:95]
buffer_load_dwordx4 v247, s[12:15], s51 offen offset:3072 nt lds
v_mfma_f32_16x16x32_bf16 v[96:99], v[112:115], a[136:139], v[96:99]
v_mfma_f32_16x16x32_bf16 v[100:103], v[116:119], a[136:139], v[100:103]
v_mfma_f32_16x16x32_bf16 v[104:107], v[120:123], a[136:139], v[104:107]
v_mfma_f32_16x16x32_bf16 v[108:111], v[124:127], a[136:139], v[108:111]
s_waitcnt vmcnt(8) lgkmcnt(0)
s_barrier
v_mfma_f32_16x16x32_bf16 v[0:3], v[128:131], a[140:143], v[0:3]
ds_read_b64_tr_b16 v[112:113], v178 offset:0
v_mfma_f32_16x16x32_bf16 v[4:7], v[132:135], a[140:143], v[4:7]
ds_read_b64_tr_b16 v[114:115], v178 offset:512
s_add_u32 m0, s50, 20480
v_mfma_f32_16x16x32_bf16 v[8:11], v[136:139], a[140:143], v[8:11]
ds_read_b64_tr_b16 v[116:117], v178 offset:8
s_add_u32 s51, s56, 12288
s_xor_b32 s51, s51, s33
v_mfma_f32_16x16x32_bf16 v[12:15], v[140:143], a[140:143], v[12:15]
buffer_load_dwordx4 v244, s[12:15], s51 offen offset:0 nt lds
v_mfma_f32_16x16x32_bf16 v[16:19], v[128:131], a[144:147], v[16:19]
ds_read_b64_tr_b16 v[118:119], v178 offset:520
v_mfma_f32_16x16x32_bf16 v[20:23], v[132:135], a[144:147], v[20:23]
ds_read_b64_tr_b16 v[120:121], v179 offset:0
v_mfma_f32_16x16x32_bf16 v[24:27], v[136:139], a[144:147], v[24:27]
ds_read_b64_tr_b16 v[122:123], v179 offset:512
v_mfma_f32_16x16x32_bf16 v[28:31], v[140:143], a[144:147], v[28:31]
buffer_load_dwordx4 v245, s[12:15], s51 offen offset:1024 nt lds
v_mfma_f32_16x16x32_bf16 v[32:35], v[128:131], a[148:151], v[32:35]
ds_read_b64_tr_b16 v[124:125], v179 offset:8
v_mfma_f32_16x16x32_bf16 v[36:39], v[132:135], a[148:151], v[36:39]
ds_read_b64_tr_b16 v[126:127], v179 offset:520
v_mfma_f32_16x16x32_bf16 v[40:43], v[136:139], a[148:151], v[40:43]
ds_read_b128 a[112:115], v176 offset:0
v_mfma_f32_16x16x32_bf16 v[44:47], v[140:143], a[148:151], v[44:47]
buffer_load_dwordx4 v246, s[12:15], s51 offen offset:2048 nt lds
v_mfma_f32_16x16x32_bf16 v[48:51], v[128:131], a[152:155], v[48:51]
ds_read_b128 a[116:119], v176 offset:2048
v_mfma_f32_16x16x32_bf16 v[52:55], v[132:135], a[152:155], v[52:55]
ds_read_b128 a[120:123], v176 offset:4096
v_mfma_f32_16x16x32_bf16 v[56:59], v[136:139], a[152:155], v[56:59]
ds_read_b128 a[124:127], v176 offset:6144
v_mfma_f32_16x16x32_bf16 v[60:63], v[140:143], a[152:155], v[60:63]
buffer_load_dwordx4 v247, s[12:15], s51 offen offset:3072 nt lds
v_mfma_f32_16x16x32_bf16 v[64:67], v[128:131], a[156:159], v[64:67]
ds_read_b128 a[128:131], v176 offset:8192
v_mfma_f32_16x16x32_bf16 v[68:71], v[132:135], a[156:159], v[68:71]
ds_read_b128 a[132:135], v176 offset:10240
v_mfma_f32_16x16x32_bf16 v[72:75], v[136:139], a[156:159], v[72:75]
ds_read_b128 a[136:139], v176 offset:12288
v_mfma_f32_16x16x32_bf16 v[76:79], v[140:143], a[156:159], v[76:79]
v_mfma_f32_16x16x32_bf16 v[80:83], v[128:131], a[160:163], v[80:83]
v_mfma_f32_16x16x32_bf16 v[84:87], v[132:135], a[160:163], v[84:87]
v_mfma_f32_16x16x32_bf16 v[88:91], v[136:139], a[160:163], v[88:91]
v_mfma_f32_16x16x32_bf16 v[92:95], v[140:143], a[160:163], v[92:95]
v_mfma_f32_16x16x32_bf16 v[96:99], v[128:131], a[164:167], v[96:99]
v_mfma_f32_16x16x32_bf16 v[100:103], v[132:135], a[164:167], v[100:103]
v_mfma_f32_16x16x32_bf16 v[104:107], v[136:139], a[164:167], v[104:107]
v_mfma_f32_16x16x32_bf16 v[108:111], v[140:143], a[164:167], v[108:111]
s_waitcnt vmcnt(8) lgkmcnt(0)
v_mfma_f32_16x16x32_bf16 v[0:3], v[112:115], a[112:115], v[0:3]
ds_read_b64_tr_b16 v[128:129], v178 offset:4096
v_mfma_f32_16x16x32_bf16 v[4:7], v[116:119], a[112:115], v[4:7]
ds_read_b64_tr_b16 v[130:131], v178 offset:4608
v_mfma_f32_16x16x32_bf16 v[8:11], v[120:123], a[112:115], v[8:11]
ds_read_b64_tr_b16 v[132:133], v178 offset:4104
v_mfma_f32_16x16x32_bf16 v[12:15], v[124:127], a[112:115], v[12:15]
v_mfma_f32_16x16x32_bf16 v[16:19], v[112:115], a[116:119], v[16:19]
ds_read_b64_tr_b16 v[134:135], v178 offset:4616
v_mfma_f32_16x16x32_bf16 v[20:23], v[116:119], a[116:119], v[20:23]
ds_read_b64_tr_b16 v[136:137], v179 offset:4096
v_mfma_f32_16x16x32_bf16 v[24:27], v[120:123], a[116:119], v[24:27]
ds_read_b64_tr_b16 v[138:139], v179 offset:4608
v_mfma_f32_16x16x32_bf16 v[28:31], v[124:127], a[116:119], v[28:31]
v_mfma_f32_16x16x32_bf16 v[32:35], v[112:115], a[120:123], v[32:35]
ds_read_b64_tr_b16 v[140:141], v179 offset:4104
v_mfma_f32_16x16x32_bf16 v[36:39], v[116:119], a[120:123], v[36:39]
ds_read_b64_tr_b16 v[142:143], v179 offset:4616
v_mfma_f32_16x16x32_bf16 v[40:43], v[120:123], a[120:123], v[40:43]
ds_read_b128 a[140:143], v177 offset:0
v_mfma_f32_16x16x32_bf16 v[44:47], v[124:127], a[120:123], v[44:47]
v_mfma_f32_16x16x32_bf16 v[48:51], v[112:115], a[124:127], v[48:51]
ds_read_b128 a[144:147], v177 offset:2048
v_mfma_f32_16x16x32_bf16 v[52:55], v[116:119], a[124:127], v[52:55]
ds_read_b128 a[148:151], v177 offset:4096
v_mfma_f32_16x16x32_bf16 v[56:59], v[120:123], a[124:127], v[56:59]
ds_read_b128 a[152:155], v177 offset:6144
v_mfma_f32_16x16x32_bf16 v[60:63], v[124:127], a[124:127], v[60:63]
v_mfma_f32_16x16x32_bf16 v[64:67], v[112:115], a[128:131], v[64:67]
ds_read_b128 a[156:159], v177 offset:8192
v_mfma_f32_16x16x32_bf16 v[68:71], v[116:119], a[128:131], v[68:71]
ds_read_b128 a[160:163], v177 offset:10240
v_mfma_f32_16x16x32_bf16 v[72:75], v[120:123], a[128:131], v[72:75]
ds_read_b128 a[164:167], v177 offset:12288
v_mfma_f32_16x16x32_bf16 v[76:79], v[124:127], a[128:131], v[76:79]
v_mfma_f32_16x16x32_bf16 v[80:83], v[112:115], a[132:135], v[80:83]
v_mfma_f32_16x16x32_bf16 v[84:87], v[116:119], a[132:135], v[84:87]
v_mfma_f32_16x16x32_bf16 v[88:91], v[120:123], a[132:135], v[88:91]
v_mfma_f32_16x16x32_bf16 v[92:95], v[124:127], a[132:135], v[92:95]
v_mfma_f32_16x16x32_bf16 v[96:99], v[112:115], a[136:139], v[96:99]
v_mfma_f32_16x16x32_bf16 v[100:103], v[116:119], a[136:139], v[100:103]
v_mfma_f32_16x16x32_bf16 v[104:107], v[120:123], a[136:139], v[104:107]
buffer_store_dwordx4 v[192:195], v250, s[20:23], s101 offen sc1
v_mfma_f32_16x16x32_bf16 v[108:111], v[124:127], a[136:139], v[108:111]
s_waitcnt lgkmcnt(0)
s_barrier
v_lshlrev_b32 v190, 3, v250
s_add_u32 m0, s50, 30720
s_cmp_eq_u32 s25, 1
s_cbranch_scc1 L1_tqb
s_cmp_eq_u32 s49, 1
s_cbranch_scc1 L1_tqk
s_xor_b32 s51, s33, 8192
buffer_load_dword v190, s[16:19], s51 offen  lds
s_branch L1_notq
L1_tqk:
s_xor_b32 s51, s33, 16384
buffer_load_dword v190, s[12:15], s51 offen  lds
s_branch L1_notq
L1_tqb:
L1_notq:
v_mfma_f32_16x16x32_bf16 v[0:3], v[128:131], a[140:143], v[0:3]
v_mfma_f32_16x16x32_bf16 v[4:7], v[132:135], a[140:143], v[4:7]
v_mfma_f32_16x16x32_bf16 v[8:11], v[136:139], a[140:143], v[8:11]
v_mfma_f32_16x16x32_bf16 v[12:15], v[140:143], a[140:143], v[12:15]
s_nop 5
v_mfma_f32_16x16x32_bf16 v[16:19], v[128:131], a[144:147], v[16:19]
v_mul_f32 v0, s58, v0
v_mul_f32 v1, s58, v1
v_mul_f32 v2, s58, v2
v_mul_f32 v3, s58, v3
v_mul_f32 v4, s58, v4
v_mul_f32 v5, s58, v5
v_mfma_f32_16x16x32_bf16 v[20:23], v[132:135], a[144:147], v[20:23]
v_mul_f32 v6, s58, v6
v_mul_f32 v7, s58, v7
v_cvt_pk_bf16_f32 v0, v0, v1
v_cvt_pk_bf16_f32 v1, v2, v3
v_cvt_pk_bf16_f32 v2, v4, v5
v_cvt_pk_bf16_f32 v3, v6, v7
v_mfma_f32_16x16x32_bf16 v[24:27], v[136:139], a[144:147], v[24:27]
ds_write_b128 v253, v[0:3] offset:0
v_accvgpr_write_b32 a0, v0
v_accvgpr_write_b32 a1, v1
v_accvgpr_write_b32 a2, v2
v_accvgpr_write_b32 a3, v3
v_mul_f32 v8, s58, v8
v_mfma_f32_16x16x32_bf16 v[28:31], v[140:143], a[144:147], v[28:31]
v_mul_f32 v9, s58, v9
v_mul_f32 v10, s58, v10
v_mul_f32 v11, s58, v11
v_mul_f32 v12, s58, v12
v_mul_f32 v13, s58, v13
v_mul_f32 v14, s58, v14
v_mul_f32 v15, s58, v15
v_cvt_pk_bf16_f32 v8, v8, v9
v_cvt_pk_bf16_f32 v9, v10, v11
v_cvt_pk_bf16_f32 v10, v12, v13
v_cvt_pk_bf16_f32 v11, v14, v15
ds_write_b128 v253, v[8:11] offset:1024
v_accvgpr_write_b32 a4, v8
v_accvgpr_write_b32 a5, v9
v_accvgpr_write_b32 a6, v10
v_accvgpr_write_b32 a7, v11
v_mfma_f32_16x16x32_bf16 v[32:35], v[128:131], a[148:151], v[32:35]
v_mul_f32 v16, s58, v16
v_mul_f32 v17, s58, v17
v_mul_f32 v18, s58, v18
v_mul_f32 v19, s58, v19
v_mul_f32 v20, s58, v20
v_mul_f32 v21, s58, v21
v_mfma_f32_16x16x32_bf16 v[36:39], v[132:135], a[148:151], v[36:39]
v_mul_f32 v22, s58, v22
v_mul_f32 v23, s58, v23
v_cvt_pk_bf16_f32 v16, v16, v17
v_cvt_pk_bf16_f32 v17, v18, v19
v_cvt_pk_bf16_f32 v18, v20, v21
v_cvt_pk_bf16_f32 v19, v22, v23
v_mfma_f32_16x16x32_bf16 v[40:43], v[136:139], a[148:151], v[40:43]
ds_write_b128 v253, v[16:19] offset:2048
v_accvgpr_write_b32 a16, v16
v_accvgpr_write_b32 a17, v17
v_accvgpr_write_b32 a18, v18
v_accvgpr_write_b32 a19, v19
v_mul_f32 v24, s58, v24
v_mfma_f32_16x16x32_bf16 v[44:47], v[140:143], a[148:151], v[44:47]
v_mul_f32 v25, s58, v25
v_mul_f32 v26, s58, v26
v_mul_f32 v27, s58, v27
v_mul_f32 v28, s58, v28
v_mul_f32 v29, s58, v29
v_mul_f32 v30, s58, v30
v_mfma_f32_32x32x16_bf16 v[0:15], v[192:195], v[192:195], 0
v_mul_f32 v31, s58, v31
v_cvt_pk_bf16_f32 v24, v24, v25
v_cvt_pk_bf16_f32 v25, v26, v27
v_cvt_pk_bf16_f32 v26, v28, v29
v_cvt_pk_bf16_f32 v27, v30, v31
ds_write_b128 v253, v[24:27] offset:3072
v_accvgpr_write_b32 a20, v24
v_accvgpr_write_b32 a21, v25
v_accvgpr_write_b32 a22, v26
v_accvgpr_write_b32 a23, v27
v_mfma_f32_16x16x32_bf16 v[48:51], v[128:131], a[152:155], v[48:51]
v_mul_f32 v32, s58, v32
v_mul_f32 v33, s58, v33
v_mul_f32 v34, s58, v34
v_mul_f32 v35, s58, v35
v_mul_f32 v36, s58, v36
v_mul_f32 v37, s58, v37
v_mfma_f32_16x16x32_bf16 v[52:55], v[132:135], a[152:155], v[52:55]
v_mul_f32 v38, s58, v38
v_mul_f32 v39, s58, v39
v_cvt_pk_bf16_f32 v32, v32, v33
v_cvt_pk_bf16_f32 v33, v34, v35
v_cvt_pk_bf16_f32 v34, v36, v37
v_cvt_pk_bf16_f32 v35, v38, v39
v_mfma_f32_16x16x32_bf16 v[56:59], v[136:139], a[152:155], v[56:59]
ds_write_b128 v253, v[32:35] offset:4096
v_accvgpr_write_b32 a32, v32
v_accvgpr_write_b32 a33, v33
v_accvgpr_write_b32 a34, v34
v_accvgpr_write_b32 a35, v35
v_mul_f32 v40, s58, v40
v_mfma_f32_16x16x32_bf16 v[60:63], v[140:143], a[152:155], v[60:63]
v_mul_f32 v41, s58, v41
v_mul_f32 v42, s58, v42
v_mul_f32 v43, s58, v43
v_mul_f32 v44, s58, v44
v_mul_f32 v45, s58, v45
v_mul_f32 v46, s58, v46
v_mfma_f32_32x32x16_bf16 v[16:31], v[192:195], v[192:195], 0
v_mul_f32 v47, s58, v47
v_cvt_pk_bf16_f32 v40, v40, v41
v_cvt_pk_bf16_f32 v41, v42, v43
v_cvt_pk_bf16_f32 v42, v44, v45
v_cvt_pk_bf16_f32 v43, v46, v47
ds_write_b128 v253, v[40:43] offset:5120
v_accvgpr_write_b32 a36, v40
v_accvgpr_write_b32 a37, v41
v_accvgpr_write_b32 a38, v42
v_accvgpr_write_b32 a39, v43
v_mfma_f32_16x16x32_bf16 v[64:67], v[128:131], a[156:159], v[64:67]
v_mul_f32 v48, s58, v48
v_mul_f32 v49, s58, v49
v_mul_f32 v50, s58, v50
v_mul_f32 v51, s58, v51
v_mul_f32 v52, s58, v52
v_mul_f32 v53, s58, v53
v_mfma_f32_16x16x32_bf16 v[68:71], v[132:135], a[156:159], v[68:71]
v_mul_f32 v54, s58, v54
v_mul_f32 v55, s58, v55
v_cvt_pk_bf16_f32 v48, v48, v49
v_cvt_pk_bf16_f32 v49, v50, v51
v_cvt_pk_bf16_f32 v50, v52, v53
v_cvt_pk_bf16_f32 v51, v54, v55
v_mfma_f32_16x16x32_bf16 v[72:75], v[136:139], a[156:159], v[72:75]
ds_write_b128 v253, v[48:51] offset:6144
v_accvgpr_write_b32 a48, v48
v_accvgpr_write_b32 a49, v49
v_accvgpr_write_b32 a50, v50
v_accvgpr_write_b32 a51, v51
v_mul_f32 v56, s58, v56
v_mfma_f32_16x16x32_bf16 v[76:79], v[140:143], a[156:159], v[76:79]
v_mul_f32 v57, s58, v57
v_mul_f32 v58, s58, v58
v_mul_f32 v59, s58, v59
v_mul_f32 v60, s58, v60
v_mul_f32 v61, s58, v61
v_mul_f32 v62, s58, v62
v_mfma_f32_32x32x16_bf16 v[32:47], v[192:195], v[192:195], 0
v_mul_f32 v63, s58, v63
v_cvt_pk_bf16_f32 v56, v56, v57
v_cvt_pk_bf16_f32 v57, v58, v59
v_cvt_pk_bf16_f32 v58, v60, v61
v_cvt_pk_bf16_f32 v59, v62, v63
ds_write_b128 v253, v[56:59] offset:7168
v_accvgpr_write_b32 a52, v56
v_accvgpr_write_b32 a53, v57
v_accvgpr_write_b32 a54, v58
v_accvgpr_write_b32 a55, v59
v_mfma_f32_16x16x32_bf16 v[80:83], v[128:131], a[160:163], v[80:83]
v_mul_f32 v64, s58, v64
v_mul_f32 v65, s58, v65
v_mul_f32 v66, s58, v66
v_mul_f32 v67, s58, v67
v_mul_f32 v68, s58, v68
v_mul_f32 v69, s58, v69
v_mfma_f32_16x16x32_bf16 v[84:87], v[132:135], a[160:163], v[84:87]
v_mul_f32 v70, s58, v70
v_mul_f32 v71, s58, v71
v_cvt_pk_bf16_f32 v64, v64, v65
v_cvt_pk_bf16_f32 v65, v66, v67
v_cvt_pk_bf16_f32 v66, v68, v69
v_cvt_pk_bf16_f32 v67, v70, v71
v_mfma_f32_16x16x32_bf16 v[88:91], v[136:139], a[160:163], v[88:91]
ds_write_b128 v251, v[64:67] offset:24576
v_accvgpr_write_b32 a64, v64
v_accvgpr_write_b32 a65, v65
v_accvgpr_write_b32 a66, v66
v_accvgpr_write_b32 a67, v67
v_mul_f32 v72, s58, v72
v_mfma_f32_16x16x32_bf16 v[92:95], v[140:143], a[160:163], v[92:95]
v_mul_f32 v73, s58, v73
v_mul_f32 v74, s58, v74
v_mul_f32 v75, s58, v75
v_mul_f32 v76, s58, v76
v_mul_f32 v77, s58, v77
v_mul_f32 v78, s58, v78
v_mfma_f32_32x32x16_bf16 v[48:63], v[192:195], v[192:195], 0
v_mul_f32 v79, s58, v79
v_cvt_pk_bf16_f32 v72, v72, v73
v_cvt_pk_bf16_f32 v73, v74, v75
v_cvt_pk_bf16_f32 v74, v76, v77
v_cvt_pk_bf16_f32 v75, v78, v79
ds_write_b128 v251, v[72:75] offset:25600
v_accvgpr_write_b32 a68, v72
v_accvgpr_write_b32 a69, v73
v_accvgpr_write_b32 a70, v74
v_accvgpr_write_b32 a71, v75
v_mfma_f32_16x16x32_bf16 v[96:99], v[128:131], a[164:167], v[96:99]
v_mul_f32 v80, s58, v80
v_mul_f32 v81, s58, v81
v_mul_f32 v82, s58, v82
v_mul_f32 v83, s58, v83
v_mul_f32 v84, s58, v84
v_mul_f32 v85, s58, v85
v_mfma_f32_16x16x32_bf16 v[100:103], v[132:135], a[164:167], v[100:103]
v_mul_f32 v86, s58, v86
v_mul_f32 v87, s58, v87
v_cvt_pk_bf16_f32 v80, v80, v81
v_cvt_pk_bf16_f32 v81, v82, v83
v_cvt_pk_bf16_f32 v82, v84, v85
v_cvt_pk_bf16_f32 v83, v86, v87
v_mfma_f32_16x16x32_bf16 v[104:107], v[136:139], a[164:167], v[104:107]
ds_write_b128 v251, v[80:83] offset:26624
v_accvgpr_write_b32 a80, v80
v_accvgpr_write_b32 a81, v81
v_accvgpr_write_b32 a82, v82
v_accvgpr_write_b32 a83, v83
v_mul_f32 v88, s58, v88
v_mfma_f32_16x16x32_bf16 v[108:111], v[140:143], a[164:167], v[108:111]
v_mul_f32 v89, s58, v89
v_mul_f32 v90, s58, v90
v_mul_f32 v91, s58, v91
v_mul_f32 v92, s58, v92
v_mul_f32 v93, s58, v93
v_mul_f32 v94, s58, v94
v_mfma_f32_32x32x16_bf16 v[64:79], v[192:195], v[192:195], 0
v_mul_f32 v95, s58, v95
v_cvt_pk_bf16_f32 v88, v88, v89
v_cvt_pk_bf16_f32 v89, v90, v91
v_cvt_pk_bf16_f32 v90, v92, v93
v_cvt_pk_bf16_f32 v91, v94, v95
ds_write_b128 v251, v[88:91] offset:27648
v_accvgpr_write_b32 a84, v88
v_accvgpr_write_b32 a85, v89
v_accvgpr_write_b32 a86, v90
v_accvgpr_write_b32 a87, v91
v_mfma_f32_32x32x16_bf16 a[112:127], v[192:195], v[192:195], 0
v_mul_f32 v96, s58, v96
v_mul_f32 v97, s58, v97
v_mul_f32 v98, s58, v98
v_mul_f32 v99, s58, v99
v_mul_f32 v100, s58, v100
v_mul_f32 v101, s58, v101
v_mfma_f32_32x32x16_bf16 a[128:143], v[192:195], v[192:195], 0
v_mul_f32 v102, s58, v102
v_mul_f32 v103, s58, v103
v_cvt_pk_bf16_f32 v96, v96, v97
v_cvt_pk_bf16_f32 v97, v98, v99
v_cvt_pk_bf16_f32 v98, v100, v101
v_cvt_pk_bf16_f32 v99, v102, v103
v_mfma_f32_32x32x16_bf16 a[144:159], v[192:195], v[192:195], 0
ds_write_b128 v251, v[96:99] offset:28672
v_accvgpr_write_b32 a96, v96
v_accvgpr_write_b32 a97, v97
v_accvgpr_write_b32 a98, v98
v_accvgpr_write_b32 a99, v99
v_mul_f32 v104, s58, v104
v_mfma_f32_32x32x16_bf16 a[160:175], v[192:195], v[192:195], 0
v_mul_f32 v105, s58, v105
v_mul_f32 v106, s58, v106
v_mul_f32 v107, s58, v107
v_mul_f32 v108, s58, v108
v_mul_f32 v109, s58, v109
v_mul_f32 v110, s58, v110
v_mfma_f32_32x32x16_bf16 v[80:95], v[192:195], v[192:195], 0
v_mul_f32 v111, s58, v111
v_cvt_pk_bf16_f32 v104, v104, v105
v_cvt_pk_bf16_f32 v105, v106, v107
v_cvt_pk_bf16_f32 v106, v108, v109
v_cvt_pk_bf16_f32 v107, v110, v111
ds_write_b128 v251, v[104:107] offset:29696
v_accvgpr_write_b32 a100, v104
v_accvgpr_write_b32 a101, v105
v_accvgpr_write_b32 a102, v106
v_accvgpr_write_b32 a103, v107
v_mfma_f32_32x32x16_bf16 v[96:111], v[192:195], v[192:195], 0
s_waitcnt lgkmcnt(0)
s_barrier
ds_read_b128 a[8:11], v254 offset:0
ds_read_b128 a[12:15], v254 offset:1024
ds_read_b128 a[24:27], v254 offset:2048
ds_read_b128 a[28:31], v254 offset:3072
ds_read_b128 a[40:43], v254 offset:4096
ds_read_b128 a[44:47], v254 offset:5120
ds_read_b128 a[56:59], v254 offset:6144
ds_read_b128 a[60:63], v254 offset:7168
ds_read_b128 a[72:75], v252 offset:24576
ds_read_b128 a[76:79], v252 offset:25600
ds_read_b128 a[88:91], v252 offset:26624
ds_read_b128 a[92:95], v252 offset:27648
ds_read_b128 a[104:107], v252 offset:28672
ds_read_b128 a[108:111], v252 offset:29696
L1_pass:
s_waitcnt vmcnt(16)
ds_read_b128 v[112:115], v232 offset:0
ds_read_b128 v[128:131], v232 offset:4096
ds_read_b128 v[116:119], v233 offset:0
ds_read_b128 v[132:135], v233 offset:4096
ds_read_b128 v[120:123], v234 offset:0
ds_read_b128 v[136:139], v234 offset:4096
ds_read_b128 v[124:127], v235 offset:0
ds_read_b128 v[140:143], v235 offset:4096
s_waitcnt lgkmcnt(0)
v_mfma_f32_16x16x32_bf16 v[176:179], v[112:115], a[0:3], v[200:203]
s_add_u32 m0, s50, 24576
s_add_u32 s51, s56, 8192
s_xor_b32 s51, s51, s33
buffer_load_dwordx4 v248, s[16:19], s51 offen offset:0 nt lds
v_mfma_f32_16x16x32_bf16 v[180:183], v[128:131], a[0:3], v[200:203]
buffer_load_dwordx4 v249, s[16:19], s51 offen offset:1024 nt lds
v_mfma_f32_16x16x32_bf16 v[176:179], v[116:119], a[4:7], v[176:179]
buffer_load_dwordx4 v248, s[16:19], s51 offen offset:2048 nt lds
v_mfma_f32_16x16x32_bf16 v[180:183], v[132:135], a[4:7], v[180:183]
buffer_load_dwordx4 v249, s[16:19], s51 offen offset:3072 nt lds
v_mfma_f32_16x16x32_bf16 v[176:179], v[120:123], a[8:11], v[176:179]
s_add_u32 m0, s50, 28672
s_add_u32 s51, s56, 12288
s_xor_b32 s51, s51, s33
buffer_load_dwordx4 v248, s[16:19], s51 offen offset:0 nt lds
v_mfma_f32_16x16x32_bf16 v[180:183], v[136:139], a[8:11], v[180:183]
buffer_load_dwordx4 v249, s[16:19], s51 offen offset:1024 nt lds
v_mfma_f32_16x16x32_bf16 v[176:179], v[124:127], a[12:15], v[176:179]
buffer_load_dwordx4 v248, s[16:19], s51 offen offset:2048 nt lds
v_mfma_f32_16x16x32_bf16 v[180:183], v[140:143], a[12:15], v[180:183]
buffer_load_dwordx4 v249, s[16:19], s51 offen offset:3072 nt lds
s_add_u32 m0, s50, 0
s_add_u32 s51, s56, 16384
s_xor_b32 s51, s51, s33
buffer_load_dwordx4 v244, s[12:15], s51 offen offset:0 nt lds
buffer_load_dwordx4 v245, s[12:15], s51 offen offset:1024 nt lds
buffer_load_dwordx4 v246, s[12:15], s51 offen offset:2048 nt lds
buffer_load_dwordx4 v247, s[12:15], s51 offen offset:3072 nt lds
s_nop 1
s_cmp_eq_u32 s25, 1
s_cbranch_scc1 L1_loop1
.p2align 6
L1_loop0:
v_mfma_f32_16x16x32_bf16 v[184:187], v[112:115], a[16:19], v[204:207]
v_exp_f32 v176, v176
v_mfma_f32_16x16x32_bf16 v[188:191], v[128:131], a[16:19], v[204:207]
v_exp_f32 v177, v177
v_mfma_f32_16x16x32_bf16 v[184:187], v[116:119], a[20:23], v[184:187]
v_exp_f32 v178, v178
v_mfma_f32_16x16x32_bf16 v[188:191], v[132:135], a[20:23], v[188:191]
v_exp_f32 v179, v179
v_mfma_f32_16x16x32_bf16 v[184:187], v[120:123], a[24:27], v[184:187]
v_exp_f32 v180, v180
v_mfma_f32_16x16x32_bf16 v[188:191], v[136:139], a[24:27], v[188:191]
v_exp_f32 v181, v181
v_mfma_f32_16x16x32_bf16 v[184:187], v[124:127], a[28:31], v[184:187]
v_exp_f32 v182, v182
v_mfma_f32_16x16x32_bf16 v[188:191], v[140:143], a[28:31], v[188:191]
v_exp_f32 v183, v183
v_mfma_f32_16x16x32_bf16 a[248:251], v[228:231], v[196:199], a[248:251]
v_cvt_pk_bf16_f32 v192, v176, v177
v_cvt_pk_bf16_f32 v193, v178, v179
v_cvt_pk_bf16_f32 v194, v180, v181
v_cvt_pk_bf16_f32 v195, v182, v183
s_waitcnt vmcnt(20)
v_mfma_f32_16x16x32_bf16 v[24:27], v[144:147], v[196:199], v[24:27]
ds_read_b64_tr_b16 v[144:145], v236 offset:0
ds_read_b64_tr_b16 v[146:147], v236 offset:4096
v_mfma_f32_16x16x32_bf16 v[52:55], v[148:151], v[196:199], v[52:55]
ds_read_b64_tr_b16 v[148:149], v237 offset:0
ds_read_b64_tr_b16 v[150:151], v237 offset:4096
v_mfma_f32_16x16x32_bf16 v[80:83], v[152:155], v[196:199], v[80:83]
ds_read_b64_tr_b16 v[152:153], v238 offset:0
ds_read_b64_tr_b16 v[154:155], v238 offset:4096
v_mfma_f32_16x16x32_bf16 v[108:111], v[156:159], v[196:199], v[108:111]
ds_read_b64_tr_b16 v[156:157], v239 offset:0
ds_read_b64_tr_b16 v[158:159], v239 offset:4096
v_mfma_f32_16x16x32_bf16 a[136:139], v[160:163], v[196:199], a[136:139]
ds_read_b64_tr_b16 v[160:161], v240 offset:0
ds_read_b64_tr_b16 v[162:163], v240 offset:4096
v_mfma_f32_16x16x32_bf16 a[164:167], v[164:167], v[196:199], a[164:167]
ds_read_b64_tr_b16 v[164:165], v241 offset:0
ds_read_b64_tr_b16 v[166:167], v241 offset:4096
v_mfma_f32_16x16x32_bf16 a[192:195], v[168:171], v[196:199], a[192:195]
ds_read_b64_tr_b16 v[168:169], v242 offset:0
ds_read_b64_tr_b16 v[170:171], v242 offset:4096
v_mfma_f32_16x16x32_bf16 a[220:223], v[172:175], v[196:199], a[220:223]
ds_read_b64_tr_b16 v[172:173], v243 offset:0
ds_read_b64_tr_b16 v[174:175], v243 offset:4096
v_mfma_f32_16x16x32_bf16 v[176:179], v[112:115], a[32:35], v[208:211]
v_exp_f32 v184, v184
v_mfma_f32_16x16x32_bf16 v[180:183], v[128:131], a[32:35], v[208:211]
v_exp_f32 v185, v185
v_mfma_f32_16x16x32_bf16 v[176:179], v[116:119], a[36:39], v[176:179]
v_exp_f32 v186, v186
v_mfma_f32_16x16x32_bf16 v[180:183], v[132:135], a[36:39], v[180:183]
v_exp_f32 v187, v187
v_mfma_f32_16x16x32_bf16 v[176:179], v[120:123], a[40:43], v[176:179]
v_exp_f32 v188, v188
v_mfma_f32_16x16x32_bf16 v[180:183], v[136:139], a[40:43], v[180:183]
v_exp_f32 v189, v189
v_mfma_f32_16x16x32_bf16 v[176:179], v[124:127], a[44:47], v[176:179]
v_exp_f32 v190, v190
v_mfma_f32_16x16x32_bf16 v[180:183], v[140:143], a[44:47], v[180:183]
v_exp_f32 v191, v191
s_waitcnt lgkmcnt(0)
v_mfma_f32_16x16x32_bf16 a[224:227], v[228:231], v[192:195], a[224:227]
v_cvt_pk_bf16_f32 v196, v184, v185
v_cvt_pk_bf16_f32 v197, v186, v187
v_mfma_f32_16x16x32_bf16 v[0:3], v[144:147], v[192:195], v[0:3]
v_cvt_pk_bf16_f32 v198, v188, v189
v_cvt_pk_bf16_f32 v199, v190, v191
v_mfma_f32_16x16x32_bf16 v[28:31], v[148:151], v[192:195], v[28:31]
s_add_u32 m0, s50, 4096
s_add_u32 s51, s56, 20480
s_xor_b32 s51, s51, s33
buffer_load_dwordx4 v244, s[12:15], s51 offen offset:0  lds
v_mfma_f32_16x16x32_bf16 v[56:59], v[152:155], v[192:195], v[56:59]
v_mfma_f32_16x16x32_bf16 v[84:87], v[156:159], v[192:195], v[84:87]
buffer_load_dwordx4 v245, s[12:15], s51 offen offset:1024  lds
v_mfma_f32_16x16x32_bf16 a[112:115], v[160:163], v[192:195], a[112:115]
v_mfma_f32_16x16x32_bf16 a[140:143], v[164:167], v[192:195], a[140:143]
buffer_load_dwordx4 v246, s[12:15], s51 offen offset:2048  lds
v_mfma_f32_16x16x32_bf16 a[168:171], v[168:171], v[192:195], a[168:171]
v_mfma_f32_16x16x32_bf16 a[196:199], v[172:175], v[192:195], a[196:199]
buffer_load_dwordx4 v247, s[12:15], s51 offen offset:3072  lds
v_mfma_f32_16x16x32_bf16 v[184:187], v[112:115], a[48:51], v[212:215]
v_exp_f32 v176, v176
v_mfma_f32_16x16x32_bf16 v[188:191], v[128:131], a[48:51], v[212:215]
v_exp_f32 v177, v177
v_mfma_f32_16x16x32_bf16 v[184:187], v[116:119], a[52:55], v[184:187]
v_exp_f32 v178, v178
v_mfma_f32_16x16x32_bf16 v[188:191], v[132:135], a[52:55], v[188:191]
v_exp_f32 v179, v179
v_mfma_f32_16x16x32_bf16 v[184:187], v[120:123], a[56:59], v[184:187]
v_exp_f32 v180, v180
v_mfma_f32_16x16x32_bf16 v[188:191], v[136:139], a[56:59], v[188:191]
v_exp_f32 v181, v181
v_mfma_f32_16x16x32_bf16 v[184:187], v[124:127], a[60:63], v[184:187]
v_exp_f32 v182, v182
v_mfma_f32_16x16x32_bf16 v[188:191], v[140:143], a[60:63], v[188:191]
v_exp_f32 v183, v183
v_mfma_f32_16x16x32_bf16 a[228:231], v[228:231], v[196:199], a[228:231]
v_cvt_pk_bf16_f32 v192, v176, v177
v_cvt_pk_bf16_f32 v193, v178, v179
v_mfma_f32_16x16x32_bf16 v[4:7], v[144:147], v[196:199], v[4:7]
v_cvt_pk_bf16_f32 v194, v180, v181
v_cvt_pk_bf16_f32 v195, v182, v183
v_mfma_f32_16x16x32_bf16 v[32:35], v[148:151], v[196:199], v[32:35]
s_add_u32 m0, s50, 8192
s_add_u32 s51, s56, 16384
s_xor_b32 s51, s51, s33
buffer_load_dwordx4 v248, s[16:19], s51 offen offset:0  lds
v_mfma_f32_16x16x32_bf16 v[60:63], v[152:155], v[196:199], v[60:63]
v_mfma_f32_16x16x32_bf16 v[88:91], v[156:159], v[196:199], v[88:91]
buffer_load_dwordx4 v249, s[16:19], s51 offen offset:1024  lds
v_mfma_f32_16x16x32_bf16 a[116:119], v[160:163], v[196:199], a[116:119]
v_mfma_f32_16x16x32_bf16 a[144:147], v[164:167], v[196:199], a[144:147]
buffer_load_dwordx4 v248, s[16:19], s51 offen offset:2048  lds
v_mfma_f32_16x16x32_bf16 a[172:175], v[168:171], v[196:199], a[172:175]
v_mfma_f32_16x16x32_bf16 a[200:203], v[172:175], v[196:199], a[200:203]
buffer_load_dwordx4 v249, s[16:19], s51 offen offset:3072  lds
v_mfma_f32_16x16x32_bf16 v[176:179], v[112:115], a[64:67], v[216:219]
v_exp_f32 v184, v184
v_mfma_f32_16x16x32_bf16 v[180:183], v[128:131], a[64:67], v[216:219]
v_exp_f32 v185, v185
v_mfma_f32_16x16x32_bf16 v[176:179], v[116:119], a[68:71], v[176:179]
v_exp_f32 v186, v186
v_mfma_f32_16x16x32_bf16 v[180:183], v[132:135], a[68:71], v[180:183]
v_exp_f32 v187, v187
v_mfma_f32_16x16x32_bf16 v[176:179], v[120:123], a[72:75], v[176:179]
v_exp_f32 v188, v188
v_mfma_f32_16x16x32_bf16 v[180:183], v[136:139], a[72:75], v[180:183]
v_exp_f32 v189, v189
v_mfma_f32_16x16x32_bf16 v[176:179], v[124:127], a[76:79], v[176:179]
v_exp_f32 v190, v190
v_mfma_f32_16x16x32_bf16 v[180:183], v[140:143], a[76:79], v[180:183]
v_exp_f32 v191, v191
v_mfma_f32_16x16x32_bf16 a[232:235], v[228:231], v[192:195], a[232:235]
v_cvt_pk_bf16_f32 v196, v184, v185
v_cvt_pk_bf16_f32 v197, v186, v187
v_mfma_f32_16x16x32_bf16 v[8:11], v[144:147], v[192:195], v[8:11]
v_cvt_pk_bf16_f32 v198, v188, v189
v_cvt_pk_bf16_f32 v199, v190, v191
v_mfma_f32_16x16x32_bf16 v[36:39], v[148:151], v[192:195], v[36:39]
s_add_u32 m0, s50, 12288
s_add_u32 s51, s56, 20480
s_xor_b32 s51, s51, s33
buffer_load_dwordx4 v248, s[16:19], s51 offen offset:0  lds
v_mfma_f32_16x16x32_bf16 v[64:67], v[152:155], v[192:195], v[64:67]
v_mfma_f32_16x16x32_bf16 v[92:95], v[156:159], v[192:195], v[92:95]
buffer_load_dwordx4 v249, s[16:19], s51 offen offset:1024  lds
v_mfma_f32_16x16x32_bf16 a[120:123], v[160:163], v[192:195], a[120:123]
v_mfma_f32_16x16x32_bf16 a[148:151], v[164:167], v[192:195], a[148:151]
buffer_load_dwordx4 v248, s[16:19], s51 offen offset:2048  lds
v_mfma_f32_16x16x32_bf16 a[176:179], v[168:171], v[192:195], a[176:179]
v_mfma_f32_16x16x32_bf16 a[204:207], v[172:175], v[192:195], a[204:207]
buffer_load_dwordx4 v249, s[16:19], s51 offen offset:3072  lds
v_mfma_f32_16x16x32_bf16 v[184:187], v[112:115], a[80:83], v[220:223]
v_exp_f32 v176, v176
v_mfma_f32_16x16x32_bf16 v[188:191], v[128:131], a[80:83], v[220:223]
v_exp_f32 v177, v177
v_mfma_f32_16x16x32_bf16 v[184:187], v[116:119], a[84:87], v[184:187]
v_exp_f32 v178, v178
v_mfma_f32_16x16x32_bf16 v[188:191], v[132:135], a[84:87], v[188:191]
v_exp_f32 v179, v179
v_mfma_f32_16x16x32_bf16 v[184:187], v[120:123], a[88:91], v[184:187]
v_exp_f32 v180, v180
v_mfma_f32_16x16x32_bf16 v[188:191], v[136:139], a[88:91], v[188:191]
v_exp_f32 v181, v181
v_mfma_f32_16x16x32_bf16 v[184:187], v[124:127], a[92:95], v[184:187]
v_exp_f32 v182, v182
v_mfma_f32_16x16x32_bf16 v[188:191], v[140:143], a[92:95], v[188:191]
v_exp_f32 v183, v183
v_mfma_f32_16x16x32_bf16 a[236:239], v[228:231], v[196:199], a[236:239]
v_cvt_pk_bf16_f32 v192, v176, v177
v_cvt_pk_bf16_f32 v193, v178, v179
v_mfma_f32_16x16x32_bf16 v[12:15], v[144:147], v[196:199], v[12:15]
v_cvt_pk_bf16_f32 v194, v180, v181
v_cvt_pk_bf16_f32 v195, v182, v183
v_mfma_f32_16x16x32_bf16 v[40:43], v[148:151], v[196:199], v[40:43]
v_mfma_f32_16x16x32_bf16 v[68:71], v[152:155], v[196:199], v[68:71]
v_mfma_f32_16x16x32_bf16 v[96:99], v[156:159], v[196:199], v[96:99]
v_mfma_f32_16x16x32_bf16 a[124:127], v[160:163], v[196:199], a[124:127]
v_mfma_f32_16x16x32_bf16 a[152:155], v[164:167], v[196:199], a[152:155]
v_mfma_f32_16x16x32_bf16 a[180:183], v[168:171], v[196:199], a[180:183]
v_mfma_f32_16x16x32_bf16 a[208:211], v[172:175], v[196:199], a[208:211]
s_waitcnt vmcnt(24)
v_mfma_f32_16x16x32_bf16 v[176:179], v[112:115], a[96:99], v[224:227]
ds_read_b128 v[112:115], v232 offset:16384
v_mfma_f32_16x16x32_bf16 v[180:183], v[128:131], a[96:99], v[224:227]
ds_read_b128 v[128:131], v232 offset:20480
v_mfma_f32_16x16x32_bf16 v[176:179], v[116:119], a[100:103], v[176:179]
ds_read_b128 v[116:119], v233 offset:16384
v_mfma_f32_16x16x32_bf16 v[180:183], v[132:135], a[100:103], v[180:183]
ds_read_b128 v[132:135], v233 offset:20480
v_mfma_f32_16x16x32_bf16 v[176:179], v[120:123], a[104:107], v[176:179]
ds_read_b128 v[120:123], v234 offset:16384
v_mfma_f32_16x16x32_bf16 v[180:183], v[136:139], a[104:107], v[180:183]
ds_read_b128 v[136:139], v234 offset:20480
v_mfma_f32_16x16x32_bf16 v[176:179], v[124:127], a[108:111], v[176:179]
ds_read_b128 v[124:127], v235 offset:16384
v_mfma_f32_16x16x32_bf16 v[180:183], v[140:143], a[108:111], v[180:183]
ds_read_b128 v[140:143], v235 offset:20480
v_exp_f32 v184, v184
v_mfma_f32_16x16x32_bf16 a[240:243], v[228:231], v[192:195], a[240:243]
v_exp_f32 v185, v185
v_mfma_f32_16x16x32_bf16 v[16:19], v[144:147], v[192:195], v[16:19]
v_exp_f32 v186, v186
v_mfma_f32_16x16x32_bf16 v[44:47], v[148:151], v[192:195], v[44:47]
v_exp_f32 v187, v187
v_mfma_f32_16x16x32_bf16 v[72:75], v[152:155], v[192:195], v[72:75]
v_exp_f32 v188, v188
v_mfma_f32_16x16x32_bf16 v[100:103], v[156:159], v[192:195], v[100:103]
v_exp_f32 v189, v189
v_mfma_f32_16x16x32_bf16 a[128:131], v[160:163], v[192:195], a[128:131]
v_exp_f32 v190, v190
v_mfma_f32_16x16x32_bf16 a[156:159], v[164:167], v[192:195], a[156:159]
v_exp_f32 v191, v191
v_mfma_f32_16x16x32_bf16 a[184:187], v[168:171], v[192:195], a[184:187]
v_cvt_pk_bf16_f32 v196, v184, v185
v_cvt_pk_bf16_f32 v197, v186, v187
v_mfma_f32_16x16x32_bf16 a[212:215], v[172:175], v[192:195], a[212:215]
v_cvt_pk_bf16_f32 v198, v188, v189
v_cvt_pk_bf16_f32 v199, v190, v191
s_waitcnt lgkmcnt(0)
v_mfma_f32_16x16x32_bf16 v[184:187], v[112:115], a[0:3], v[200:203]
v_exp_f32 v176, v176
v_mfma_f32_16x16x32_bf16 v[188:191], v[128:131], a[0:3], v[200:203]
v_exp_f32 v177, v177
v_mfma_f32_16x16x32_bf16 v[184:187], v[116:119], a[4:7], v[184:187]
v_exp_f32 v178, v178
v_mfma_f32_16x16x32_bf16 v[188:191], v[132:135], a[4:7], v[188:191]
v_exp_f32 v179, v179
v_mfma_f32_16x16x32_bf16 v[184:187], v[120:123], a[8:11], v[184:187]
v_exp_f32 v180, v180
v_mfma_f32_16x16x32_bf16 v[188:191], v[136:139], a[8:11], v[188:191]
v_exp_f32 v181, v181
v_mfma_f32_16x16x32_bf16 v[184:187], v[124:127], a[12:15], v[184:187]
v_exp_f32 v182, v182
v_mfma_f32_16x16x32_bf16 v[188:191], v[140:143], a[12:15], v[188:191]
v_exp_f32 v183, v183
v_mfma_f32_16x16x32_bf16 a[244:247], v[228:231], v[196:199], a[244:247]
v_cvt_pk_bf16_f32 v192, v176, v177
v_cvt_pk_bf16_f32 v193, v178, v179
v_mfma_f32_16x16x32_bf16 v[20:23], v[144:147], v[196:199], v[20:23]
v_cvt_pk_bf16_f32 v194, v180, v181
v_cvt_pk_bf16_f32 v195, v182, v183
v_mfma_f32_16x16x32_bf16 v[48:51], v[148:151], v[196:199], v[48:51]
s_add_u32 m0, s50, 16384
s_add_u32 s51, s56, 24576
s_xor_b32 s51, s51, s33
buffer_load_dwordx4 v244, s[12:15], s51 offen offset:0  lds
v_mfma_f32_16x16x32_bf16 v[76:79], v[152:155], v[196:199], v[76:79]
v_mfma_f32_16x16x32_bf16 v[104:107], v[156:159], v[196:199], v[104:107]
buffer_load_dwordx4 v245, s[12:15], s51 offen offset:1024  lds
v_mfma_f32_16x16x32_bf16 a[132:135], v[160:163], v[196:199], a[132:135]
v_mfma_f32_16x16x32_bf16 a[160:163], v[164:167], v[196:199], a[160:163]
buffer_load_dwordx4 v246, s[12:15], s51 offen offset:2048  lds
v_mfma_f32_16x16x32_bf16 a[188:191], v[168:171], v[196:199], a[188:191]
v_mfma_f32_16x16x32_bf16 a[216:219], v[172:175], v[196:199], a[216:219]
buffer_load_dwordx4 v247, s[12:15], s51 offen offset:3072  lds
v_mfma_f32_16x16x32_bf16 v[176:179], v[112:115], a[16:19], v[204:207]
v_exp_f32 v184, v184
v_mfma_f32_16x16x32_bf16 v[180:183], v[128:131], a[16:19], v[204:207]
v_exp_f32 v185, v185
v_mfma_f32_16x16x32_bf16 v[176:179], v[116:119], a[20:23], v[176:179]
v_exp_f32 v186, v186
v_mfma_f32_16x16x32_bf16 v[180:183], v[132:135], a[20:23], v[180:183]
v_exp_f32 v187, v187
v_mfma_f32_16x16x32_bf16 v[176:179], v[120:123], a[24:27], v[176:179]
v_exp_f32 v188, v188
v_mfma_f32_16x16x32_bf16 v[180:183], v[136:139], a[24:27], v[180:183]
v_exp_f32 v189, v189
v_mfma_f32_16x16x32_bf16 v[176:179], v[124:127], a[28:31], v[176:179]
v_exp_f32 v190, v190
v_mfma_f32_16x16x32_bf16 v[180:183], v[140:143], a[28:31], v[180:183]
v_exp_f32 v191, v191
v_mfma_f32_16x16x32_bf16 a[248:251], v[228:231], v[192:195], a[248:251]
v_cvt_pk_bf16_f32 v196, v184, v185
v_cvt_pk_bf16_f32 v197, v186, v187
v_cvt_pk_bf16_f32 v198, v188, v189
v_cvt_pk_bf16_f32 v199, v190, v191
s_waitcnt vmcnt(20)
v_mfma_f32_16x16x32_bf16 v[24:27], v[144:147], v[192:195], v[24:27]
ds_read_b64_tr_b16 v[144:145], v236 offset:16384
ds_read_b64_tr_b16 v[146:147], v236 offset:20480
v_mfma_f32_16x16x32_bf16 v[52:55], v[148:151], v[192:195], v[52:55]
ds_read_b64_tr_b16 v[148:149], v237 offset:16384
ds_read_b64_tr_b16 v[150:151], v237 offset:20480
v_mfma_f32_16x16x32_bf16 v[80:83], v[152:155], v[192:195], v[80:83]
ds_read_b64_tr_b16 v[152:153], v238 offset:16384
ds_read_b64_tr_b16 v[154:155], v238 offset:20480
v_mfma_f32_16x16x32_bf16 v[108:111], v[156:159], v[192:195], v[108:111]
ds_read_b64_tr_b16 v[156:157], v239 offset:16384
ds_read_b64_tr_b16 v[158:159], v239 offset:20480
v_mfma_f32_16x16x32_bf16 a[136:139], v[160:163], v[192:195], a[136:139]
ds_read_b64_tr_b16 v[160:161], v240 offset:16384
ds_read_b64_tr_b16 v[162:163], v240 offset:20480
v_mfma_f32_16x16x32_bf16 a[164:167], v[164:167], v[192:195], a[164:167]
ds_read_b64_tr_b16 v[164:165], v241 offset:16384
ds_read_b64_tr_b16 v[166:167], v241 offset:20480
v_mfma_f32_16x16x32_bf16 a[192:195], v[168:171], v[192:195], a[192:195]
ds_read_b64_tr_b16 v[168:169], v242 offset:16384
ds_read_b64_tr_b16 v[170:171], v242 offset:20480
v_mfma_f32_16x16x32_bf16 a[220:223], v[172:175], v[192:195], a[220:223]
ds_read_b64_tr_b16 v[172:173], v243 offset:16384
ds_read_b64_tr_b16 v[174:175], v243 offset:20480
v_mfma_f32_16x16x32_bf16 v[184:187], v[112:115], a[32:35], v[208:211]
v_exp_f32 v176, v176
v_mfma_f32_16x16x32_bf16 v[188:191], v[128:131], a[32:35], v[208:211]
v_exp_f32 v177, v177
v_mfma_f32_16x16x32_bf16 v[184:187], v[116:119], a[36:39], v[184:187]
v_exp_f32 v178, v178
v_mfma_f32_16x16x32_bf16 v[188:191], v[132:135], a[36:39], v[188:191]
v_exp_f32 v179, v179
v_mfma_f32_16x16x32_bf16 v[184:187], v[120:123], a[40:43], v[184:187]
v_exp_f32 v180, v180
v_mfma_f32_16x16x32_bf16 v[188:191], v[136:139], a[40:43], v[188:191]
v_exp_f32 v181, v181
v_mfma_f32_16x16x32_bf16 v[184:187], v[124:127], a[44:47], v[184:187]
v_exp_f32 v182, v182
v_mfma_f32_16x16x32_bf16 v[188:191], v[140:143], a[44:47], v[188:191]
v_exp_f32 v183, v183
s_waitcnt lgkmcnt(0)
v_mfma_f32_16x16x32_bf16 a[224:227], v[228:231], v[196:199], a[224:227]
v_cvt_pk_bf16_f32 v192, v176, v177
v_cvt_pk_bf16_f32 v193, v178, v179
v_mfma_f32_16x16x32_bf16 v[0:3], v[144:147], v[196:199], v[0:3]
v_cvt_pk_bf16_f32 v194, v180, v181
v_cvt_pk_bf16_f32 v195, v182, v183
v_mfma_f32_16x16x32_bf16 v[28:31], v[148:151], v[196:199], v[28:31]
s_add_u32 m0, s50, 20480
s_add_u32 s51, s56, 28672
s_xor_b32 s51, s51, s33
buffer_load_dwordx4 v244, s[12:15], s51 offen offset:0  lds
v_mfma_f32_16x16x32_bf16 v[56:59], v[152:155], v[196:199], v[56:59]
v_mfma_f32_16x16x32_bf16 v[84:87], v[156:159], v[196:199], v[84:87]
buffer_load_dwordx4 v245, s[12:15], s51 offen offset:1024  lds
v_mfma_f32_16x16x32_bf16 a[112:115], v[160:163], v[196:199], a[112:115]
v_mfma_f32_16x16x32_bf16 a[140:143], v[164:167], v[196:199], a[140:143]
buffer_load_dwordx4 v246, s[12:15], s51 offen offset:2048  lds
v_mfma_f32_16x16x32_bf16 a[168:171], v[168:171], v[196:199], a[168:171]
v_mfma_f32_16x16x32_bf16 a[196:199], v[172:175], v[196:199], a[196:199]
buffer_load_dwordx4 v247, s[12:15], s51 offen offset:3072  lds
v_mfma_f32_16x16x32_bf16 v[176:179], v[112:115], a[48:51], v[212:215]
v_exp_f32 v184, v184
v_mfma_f32_16x16x32_bf16 v[180:183], v[128:131], a[48:51], v[212:215]
v_exp_f32 v185, v185
v_mfma_f32_16x16x32_bf16 v[176:179], v[116:119], a[52:55], v[176:179]
v_exp_f32 v186, v186
v_mfma_f32_16x16x32_bf16 v[180:183], v[132:135], a[52:55], v[180:183]
v_exp_f32 v187, v187
v_mfma_f32_16x16x32_bf16 v[176:179], v[120:123], a[56:59], v[176:179]
v_exp_f32 v188, v188
v_mfma_f32_16x16x32_bf16 v[180:183], v[136:139], a[56:59], v[180:183]
v_exp_f32 v189, v189
v_mfma_f32_16x16x32_bf16 v[176:179], v[124:127], a[60:63], v[176:179]
v_exp_f32 v190, v190
v_mfma_f32_16x16x32_bf16 v[180:183], v[140:143], a[60:63], v[180:183]
v_exp_f32 v191, v191
v_mfma_f32_16x16x32_bf16 a[228:231], v[228:231], v[192:195], a[228:231]
v_cvt_pk_bf16_f32 v196, v184, v185
v_cvt_pk_bf16_f32 v197, v186, v187
v_mfma_f32_16x16x32_bf16 v[4:7], v[144:147], v[192:195], v[4:7]
v_cvt_pk_bf16_f32 v198, v188, v189
v_cvt_pk_bf16_f32 v199, v190, v191
v_mfma_f32_16x16x32_bf16 v[32:35], v[148:151], v[192:195], v[32:35]
s_add_u32 m0, s50, 24576
s_add_u32 s51, s56, 24576
s_xor_b32 s51, s51, s33
buffer_load_dwordx4 v248, s[16:19], s51 offen offset:0  lds
v_mfma_f32_16x16x32_bf16 v[60:63], v[152:155], v[192:195], v[60:63]
v_mfma_f32_16x16x32_bf16 v[88:91], v[156:159], v[192:195], v[88:91]
buffer_load_dwordx4 v249, s[16:19], s51 offen offset:1024  lds
v_mfma_f32_16x16x32_bf16 a[116:119], v[160:163], v[192:195], a[116:119]
v_mfma_f32_16x16x32_bf16 a[144:147], v[164:167], v[192:195], a[144:147]
buffer_load_dwordx4 v248, s[16:19], s51 offen offset:2048  lds
v_mfma_f32_16x16x32_bf16 a[172:175], v[168:171], v[192:195], a[172:175]
v_mfma_f32_16x16x32_bf16 a[200:203], v[172:175], v[192:195], a[200:203]
buffer_load_dwordx4 v249, s[16:19], s51 offen offset:3072  lds
v_mfma_f32_16x16x32_bf16 v[184:187], v[112:115], a[64:67], v[216:219]
v_exp_f32 v176, v176
v_mfma_f32_16x16x32_bf16 v[188:191], v[128:131], a[64:67], v[216:219]
v_exp_f32 v177, v177
v_mfma_f32_16x16x32_bf16 v[184:187], v[116:119], a[68:71], v[184:187]
v_exp_f32 v178, v178
v_mfma_f32_16x16x32_bf16 v[188:191], v[132:135], a[68:71], v[188:191]
v_exp_f32 v179, v179
v_mfma_f32_16x16x32_bf16 v[184:187], v[120:123], a[72:75], v[184:187]
v_exp_f32 v180, v180
v_mfma_f32_16x16x32_bf16 v[188:191], v[136:139], a[72:75], v[188:191]
v_exp_f32 v181, v181
v_mfma_f32_16x16x32_bf16 v[184:187], v[124:127], a[76:79], v[184:187]
v_exp_f32 v182, v182
v_mfma_f32_16x16x32_bf16 v[188:191], v[140:143], a[76:79], v[188:191]
v_exp_f32 v183, v183
v_mfma_f32_16x16x32_bf16 a[232:235], v[228:231], v[196:199], a[232:235]
v_cvt_pk_bf16_f32 v192, v176, v177
v_cvt_pk_bf16_f32 v193, v178, v179
v_mfma_f32_16x16x32_bf16 v[8:11], v[144:147], v[196:199], v[8:11]
v_cvt_pk_bf16_f32 v194, v180, v181
v_cvt_pk_bf16_f32 v195, v182, v183
v_mfma_f32_16x16x32_bf16 v[36:39], v[148:151], v[196:199], v[36:39]
s_add_u32 m0, s50, 28672
s_add_u32 s51, s56, 28672
s_xor_b32 s51, s51, s33
buffer_load_dwordx4 v248, s[16:19], s51 offen offset:0  lds
v_mfma_f32_16x16x32_bf16 v[64:67], v[152:155], v[196:199], v[64:67]
v_mfma_f32_16x16x32_bf16 v[92:95], v[156:159], v[196:199], v[92:95]
buffer_load_dwordx4 v249, s[16:19], s51 offen offset:1024  lds
v_mfma_f32_16x16x32_bf16 a[120:123], v[160:163], v[196:199], a[120:123]
v_mfma_f32_16x16x32_bf16 a[148:151], v[164:167], v[196:199], a[148:151]
buffer_load_dwordx4 v248, s[16:19], s51 offen offset:2048  lds
v_mfma_f32_16x16x32_bf16 a[176:179], v[168:171], v[196:199], a[176:179]
v_mfma_f32_16x16x32_bf16 a[204:207], v[172:175], v[196:199], a[204:207]
buffer_load_dwordx4 v249, s[16:19], s51 offen offset:3072  lds
v_mfma_f32_16x16x32_bf16 v[176:179], v[112:115], a[80:83], v[220:223]
v_exp_f32 v184, v184
v_mfma_f32_16x16x32_bf16 v[180:183], v[128:131], a[80:83], v[220:223]
v_exp_f32 v185, v185
v_mfma_f32_16x16x32_bf16 v[176:179], v[116:119], a[84:87], v[176:179]
v_exp_f32 v186, v186
v_mfma_f32_16x16x32_bf16 v[180:183], v[132:135], a[84:87], v[180:183]
v_exp_f32 v187, v187
v_mfma_f32_16x16x32_bf16 v[176:179], v[120:123], a[88:91], v[176:179]
v_exp_f32 v188, v188
v_mfma_f32_16x16x32_bf16 v[180:183], v[136:139], a[88:91], v[180:183]
v_exp_f32 v189, v189
v_mfma_f32_16x16x32_bf16 v[176:179], v[124:127], a[92:95], v[176:179]
v_exp_f32 v190, v190
v_mfma_f32_16x16x32_bf16 v[180:183], v[140:143], a[92:95], v[180:183]
v_exp_f32 v191, v191
v_mfma_f32_16x16x32_bf16 a[236:239], v[228:231], v[192:195], a[236:239]
v_cvt_pk_bf16_f32 v196, v184, v185
v_cvt_pk_bf16_f32 v197, v186, v187
v_mfma_f32_16x16x32_bf16 v[12:15], v[144:147], v[192:195], v[12:15]
v_cvt_pk_bf16_f32 v198, v188, v189
v_cvt_pk_bf16_f32 v199, v190, v191
v_mfma_f32_16x16x32_bf16 v[40:43], v[148:151], v[192:195], v[40:43]
v_mfma_f32_16x16x32_bf16 v[68:71], v[152:155], v[192:195], v[68:71]
v_mfma_f32_16x16x32_bf16 v[96:99], v[156:159], v[192:195], v[96:99]
v_mfma_f32_16x16x32_bf16 a[124:127], v[160:163], v[192:195], a[124:127]
v_mfma_f32_16x16x32_bf16 a[152:155], v[164:167], v[192:195], a[152:155]
v_mfma_f32_16x16x32_bf16 a[180:183], v[168:171], v[192:195], a[180:183]
v_mfma_f32_16x16x32_bf16 a[208:211], v[172:175], v[192:195], a[208:211]
s_waitcnt vmcnt(24)
v_mfma_f32_16x16x32_bf16 v[184:187], v[112:115], a[96:99], v[224:227]
ds_read_b128 v[112:115], v232 offset:0
v_mfma_f32_16x16x32_bf16 v[188:191], v[128:131], a[96:99], v[224:227]
ds_read_b128 v[128:131], v232 offset:4096
v_mfma_f32_16x16x32_bf16 v[184:187], v[116:119], a[100:103], v[184:187]
ds_read_b128 v[116:119], v233 offset:0
v_mfma_f32_16x16x32_bf16 v[188:191], v[132:135], a[100:103], v[188:191]
ds_read_b128 v[132:135], v233 offset:4096
v_mfma_f32_16x16x32_bf16 v[184:187], v[120:123], a[104:107], v[184:187]
ds_read_b128 v[120:123], v234 offset:0
v_mfma_f32_16x16x32_bf16 v[188:191], v[136:139], a[104:107], v[188:191]
ds_read_b128 v[136:139], v234 offset:4096
v_mfma_f32_16x16x32_bf16 v[184:187], v[124:127], a[108:111], v[184:187]
ds_read_b128 v[124:127], v235 offset:0
v_mfma_f32_16x16x32_bf16 v[188:191], v[140:143], a[108:111], v[188:191]
ds_read_b128 v[140:143], v235 offset:4096
v_exp_f32 v176, v176
v_mfma_f32_16x16x32_bf16 a[240:243], v[228:231], v[196:199], a[240:243]
v_exp_f32 v177, v177
v_mfma_f32_16x16x32_bf16 v[16:19], v[144:147], v[196:199], v[16:19]
v_exp_f32 v178, v178
v_mfma_f32_16x16x32_bf16 v[44:47], v[148:151], v[196:199], v[44:47]
v_exp_f32 v179, v179
v_mfma_f32_16x16x32_bf16 v[72:75], v[152:155], v[196:199], v[72:75]
v_exp_f32 v180, v180
v_mfma_f32_16x16x32_bf16 v[100:103], v[156:159], v[196:199], v[100:103]
v_exp_f32 v181, v181
v_mfma_f32_16x16x32_bf16 a[128:131], v[160:163], v[196:199], a[128:131]
v_exp_f32 v182, v182
v_mfma_f32_16x16x32_bf16 a[156:159], v[164:167], v[196:199], a[156:159]
v_exp_f32 v183, v183
v_mfma_f32_16x16x32_bf16 a[184:187], v[168:171], v[196:199], a[184:187]
v_cvt_pk_bf16_f32 v192, v176, v177
v_cvt_pk_bf16_f32 v193, v178, v179
v_mfma_f32_16x16x32_bf16 a[212:215], v[172:175], v[196:199], a[212:215]
v_cvt_pk_bf16_f32 v194, v180, v181
v_cvt_pk_bf16_f32 v195, v182, v183
s_waitcnt lgkmcnt(0)
v_mfma_f32_16x16x32_bf16 v[176:179], v[112:115], a[0:3], v[200:203]
v_exp_f32 v184, v184
v_mfma_f32_16x16x32_bf16 v[180:183], v[128:131], a[0:3], v[200:203]
v_exp_f32 v185, v185
v_mfma_f32_16x16x32_bf16 v[176:179], v[116:119], a[4:7], v[176:179]
v_exp_f32 v186, v186
v_mfma_f32_16x16x32_bf16 v[180:183], v[132:135], a[4:7], v[180:183]
v_exp_f32 v187, v187
v_mfma_f32_16x16x32_bf16 v[176:179], v[120:123], a[8:11], v[176:179]
v_exp_f32 v188, v188
v_mfma_f32_16x16x32_bf16 v[180:183], v[136:139], a[8:11], v[180:183]
v_exp_f32 v189, v189
v_mfma_f32_16x16x32_bf16 v[176:179], v[124:127], a[12:15], v[176:179]
v_exp_f32 v190, v190
v_mfma_f32_16x16x32_bf16 v[180:183], v[140:143], a[12:15], v[180:183]
v_exp_f32 v191, v191
v_mfma_f32_16x16x32_bf16 a[244:247], v[228:231], v[192:195], a[244:247]
v_cvt_pk_bf16_f32 v196, v184, v185
v_cvt_pk_bf16_f32 v197, v186, v187
v_mfma_f32_16x16x32_bf16 v[20:23], v[144:147], v[192:195], v[20:23]
v_cvt_pk_bf16_f32 v198, v188, v189
v_cvt_pk_bf16_f32 v199, v190, v191
v_mfma_f32_16x16x32_bf16 v[48:51], v[148:151], v[192:195], v[48:51]
s_add_u32 m0, s50, 0
s_add_u32 s51, s56, 32768
s_xor_b32 s51, s51, s33
buffer_load_dwordx4 v244, s[12:15], s51 offen offset:0  lds
v_mfma_f32_16x16x32_bf16 v[76:79], v[152:155], v[192:195], v[76:79]
v_mfma_f32_16x16x32_bf16 v[104:107], v[156:159], v[192:195], v[104:107]
buffer_load_dwordx4 v245, s[12:15], s51 offen offset:1024  lds
v_mfma_f32_16x16x32_bf16 a[132:135], v[160:163], v[192:195], a[132:135]
v_mfma_f32_16x16x32_bf16 a[160:163], v[164:167], v[192:195], a[160:163]
buffer_load_dwordx4 v246, s[12:15], s51 offen offset:2048  lds
v_mfma_f32_16x16x32_bf16 a[188:191], v[168:171], v[192:195], a[188:191]
s_add_u32 s56, s56, 16384
s_cmp_lt_u32 s56, 114688
v_mfma_f32_16x16x32_bf16 a[216:219], v[172:175], v[192:195], a[216:219]
buffer_load_dwordx4 v247, s[12:15], s51 offen offset:3072  lds
s_cbranch_scc1 L1_loop0
s_branch L1_post
.p2align 6
L1_loop1:
v_mfma_f32_16x16x32_bf16 v[184:187], v[112:115], a[16:19], v[204:207]
v_exp_f32 v176, v176
v_mfma_f32_16x16x32_bf16 v[188:191], v[128:131], a[16:19], v[204:207]
v_exp_f32 v177, v177
v_mfma_f32_16x16x32_bf16 v[184:187], v[116:119], a[20:23], v[184:187]
v_exp_f32 v178, v178
v_mfma_f32_16x16x32_bf16 v[188:191], v[132:135], a[20:23], v[188:191]
v_exp_f32 v179, v179
v_mfma_f32_16x16x32_bf16 v[184:187], v[120:123], a[24:27], v[184:187]
v_exp_f32 v180, v180
v_mfma_f32_16x16x32_bf16 v[188:191], v[136:139], a[24:27], v[188:191]
v_exp_f32 v181, v181
v_mfma_f32_16x16x32_bf16 v[184:187], v[124:127], a[28:31], v[184:187]
v_exp_f32 v182, v182
v_mfma_f32_16x16x32_bf16 v[188:191], v[140:143], a[28:31], v[188:191]
v_exp_f32 v183, v183
v_mfma_f32_16x16x32_bf16 a[248:251], v[228:231], v[196:199], a[248:251]
v_cvt_pk_bf16_f32 v192, v176, v177
v_cvt_pk_bf16_f32 v193, v178, v179
v_cvt_pk_bf16_f32 v194, v180, v181
v_cvt_pk_bf16_f32 v195, v182, v183
s_waitcnt vmcnt(20)
v_mfma_f32_16x16x32_bf16 v[24:27], v[144:147], v[196:199], v[24:27]
ds_read_b64_tr_b16 v[144:145], v236 offset:0
ds_read_b64_tr_b16 v[146:147], v236 offset:4096
v_mfma_f32_16x16x32_bf16 v[52:55], v[148:151], v[196:199], v[52:55]
ds_read_b64_tr_b16 v[148:149], v237 offset:0
ds_read_b64_tr_b16 v[150:151], v237 offset:4096
v_mfma_f32_16x16x32_bf16 v[80:83], v[152:155], v[196:199], v[80:83]
ds_read_b64_tr_b16 v[152:153], v238 offset:0
ds_read_b64_tr_b16 v[154:155], v238 offset:4096
v_mfma_f32_16x16x32_bf16 v[108:111], v[156:159], v[196:199], v[108:111]
ds_read_b64_tr_b16 v[156:157], v239 offset:0
ds_read_b64_tr_b16 v[158:159], v239 offset:4096
v_mfma_f32_16x16x32_bf16 a[136:139], v[160:163], v[196:199], a[136:139]
ds_read_b64_tr_b16 v[160:161], v240 offset:0
ds_read_b64_tr_b16 v[162:163], v240 offset:4096
v_mfma_f32_16x16x32_bf16 a[164:167], v[164:167], v[196:199], a[164:167]
ds_read_b64_tr_b16 v[164:165], v241 offset:0
ds_read_b64_tr_b16 v[166:167], v241 offset:4096
v_mfma_f32_16x16x32_bf16 a[192:195], v[168:171], v[196:199], a[192:195]
ds_read_b64_tr_b16 v[168:169], v242 offset:0
ds_read_b64_tr_b16 v[170:171], v242 offset:4096
v_mfma_f32_16x16x32_bf16 a[220:223], v[172:175], v[196:199], a[220:223]
ds_read_b64_tr_b16 v[172:173], v243 offset:0
ds_read_b64_tr_b16 v[174:175], v243 offset:4096
v_mfma_f32_16x16x32_bf16 v[176:179], v[112:115], a[32:35], v[208:211]
v_exp_f32 v184, v184
v_mfma_f32_16x16x32_bf16 v[180:183], v[128:131], a[32:35], v[208:211]
v_exp_f32 v185, v185
v_mfma_f32_16x16x32_bf16 v[176:179], v[116:119], a[36:39], v[176:179]
v_exp_f32 v186, v186
v_mfma_f32_16x16x32_bf16 v[180:183], v[132:135], a[36:39], v[180:183]
v_exp_f32 v187, v187
v_mfma_f32_16x16x32_bf16 v[176:179], v[120:123], a[40:43], v[176:179]
v_exp_f32 v188, v188
v_mfma_f32_16x16x32_bf16 v[180:183], v[136:139], a[40:43], v[180:183]
v_exp_f32 v189, v189
v_mfma_f32_16x16x32_bf16 v[176:179], v[124:127], a[44:47], v[176:179]
v_exp_f32 v190, v190
v_mfma_f32_16x16x32_bf16 v[180:183], v[140:143], a[44:47], v[180:183]
v_exp_f32 v191, v191
s_waitcnt lgkmcnt(0)
v_mfma_f32_16x16x32_bf16 a[224:227], v[228:231], v[192:195], a[224:227]
v_cvt_pk_bf16_f32 v196, v184, v185
v_cvt_pk_bf16_f32 v197, v186, v187
v_mfma_f32_16x16x32_bf16 v[0:3], v[144:147], v[192:195], v[0:3]
v_cvt_pk_bf16_f32 v198, v188, v189
v_cvt_pk_bf16_f32 v199, v190, v191
v_mfma_f32_16x16x32_bf16 v[28:31], v[148:151], v[192:195], v[28:31]
s_add_u32 m0, s50, 4096
s_add_u32 s51, s56, 20480
s_xor_b32 s51, s51, s33
buffer_load_dwordx4 v244, s[12:15], s51 offen offset:0 nt lds
v_mfma_f32_16x16x32_bf16 v[56:59], v[152:155], v[192:195], v[56:59]
v_mfma_f32_16x16x32_bf16 v[84:87], v[156:159], v[192:195], v[84:87]
buffer_load_dwordx4 v245, s[12:15], s51 offen offset:1024 nt lds
v_mfma_f32_16x16x32_bf16 a[112:115], v[160:163], v[192:195], a[112:115]
v_mfma_f32_16x16x32_bf16 a[140:143], v[164:167], v[192:195], a[140:143]
buffer_load_dwordx4 v246, s[12:15], s51 offen offset:2048 nt lds
v_mfma_f32_16x16x32_bf16 a[168:171], v[168:171], v[192:195], a[168:171]
v_mfma_f32_16x16x32_bf16 a[196:199], v[172:175], v[192:195], a[196:199]
buffer_load_dwordx4 v247, s[12:15], s51 offen offset:3072 nt lds
v_mfma_f32_16x16x32_bf16 v[184:187], v[112:115], a[48:51], v[212:215]
v_exp_f32 v176, v176
v_mfma_f32_16x16x32_bf16 v[188:191], v[128:131], a[48:51], v[212:215]
v_exp_f32 v177, v177
v_mfma_f32_16x16x32_bf16 v[184:187], v[116:119], a[52:55], v[184:187]
v_exp_f32 v178, v178
v_mfma_f32_16x16x32_bf16 v[188:191], v[132:135], a[52:55], v[188:191]
v_exp_f32 v179, v179
v_mfma_f32_16x16x32_bf16 v[184:187], v[120:123], a[56:59], v[184:187]
v_exp_f32 v180, v180
v_mfma_f32_16x16x32_bf16 v[188:191], v[136:139], a[56:59], v[188:191]
v_exp_f32 v181, v181
v_mfma_f32_16x16x32_bf16 v[184:187], v[124:127], a[60:63], v[184:187]
v_exp_f32 v182, v182
v_mfma_f32_16x16x32_bf16 v[188:191], v[140:143], a[60:63], v[188:191]
v_exp_f32 v183, v183
v_mfma_f32_16x16x32_bf16 a[228:231], v[228:231], v[196:199], a[228:231]
v_cvt_pk_bf16_f32 v192, v176, v177
v_cvt_pk_bf16_f32 v193, v178, v179
v_mfma_f32_16x16x32_bf16 v[4:7], v[144:147], v[196:199], v[4:7]
v_cvt_pk_bf16_f32 v194, v180, v181
v_cvt_pk_bf16_f32 v195, v182, v183
v_mfma_f32_16x16x32_bf16 v[32:35], v[148:151], v[196:199], v[32:35]
s_add_u32 m0, s50, 8192
s_add_u32 s51, s56, 16384
s_xor_b32 s51, s51, s33
buffer_load_dwordx4 v248, s[16:19], s51 offen offset:0 nt lds
v_mfma_f32_16x16x32_bf16 v[60:63], v[152:155], v[196:199], v[60:63]
v_mfma_f32_16x16x32_bf16 v[88:91], v[156:159], v[196:199], v[88:91]
buffer_load_dwordx4 v249, s[16:19], s51 offen offset:1024 nt lds
v_mfma_f32_16x16x32_bf16 a[116:119], v[160:163], v[196:199], a[116:119]
v_mfma_f32_16x16x32_bf16 a[144:147], v[164:167], v[196:199], a[144:147]
buffer_load_dwordx4 v248, s[16:19], s51 offen offset:2048 nt lds
v_mfma_f32_16x16x32_bf16 a[172:175], v[168:171], v[196:199], a[172:175]
v_mfma_f32_16x16x32_bf16 a[200:203], v[172:175], v[196:199], a[200:203]
buffer_load_dwordx4 v249, s[16:19], s51 offen offset:3072 nt lds
v_mfma_f32_16x16x32_bf16 v[176:179], v[112:115], a[64:67], v[216:219]
v_exp_f32 v184, v184
v_mfma_f32_16x16x32_bf16 v[180:183], v[128:131], a[64:67], v[216:219]
v_exp_f32 v185, v185
v_mfma_f32_16x16x32_bf16 v[176:179], v[116:119], a[68:71], v[176:179]
v_exp_f32 v186, v186
v_mfma_f32_16x16x32_bf16 v[180:183], v[132:135], a[68:71], v[180:183]
v_exp_f32 v187, v187
v_mfma_f32_16x16x32_bf16 v[176:179], v[120:123], a[72:75], v[176:179]
v_exp_f32 v188, v188
v_mfma_f32_16x16x32_bf16 v[180:183], v[136:139], a[72:75], v[180:183]
v_exp_f32 v189, v189
v_mfma_f32_16x16x32_bf16 v[176:179], v[124:127], a[76:79], v[176:179]
v_exp_f32 v190, v190
v_mfma_f32_16x16x32_bf16 v[180:183], v[140:143], a[76:79], v[180:183]
v_exp_f32 v191, v191
v_mfma_f32_16x16x32_bf16 a[232:235], v[228:231], v[192:195], a[232:235]
v_cvt_pk_bf16_f32 v196, v184, v185
v_cvt_pk_bf16_f32 v197, v186, v187
v_mfma_f32_16x16x32_bf16 v[8:11], v[144:147], v[192:195], v[8:11]
v_cvt_pk_bf16_f32 v198, v188, v189
v_cvt_pk_bf16_f32 v199, v190, v191
v_mfma_f32_16x16x32_bf16 v[36:39], v[148:151], v[192:195], v[36:39]
s_add_u32 m0, s50, 12288
s_add_u32 s51, s56, 20480
s_xor_b32 s51, s51, s33
buffer_load_dwordx4 v248, s[16:19], s51 offen offset:0 nt lds
v_mfma_f32_16x16x32_bf16 v[64:67], v[152:155], v[192:195], v[64:67]
v_mfma_f32_16x16x32_bf16 v[92:95], v[156:159], v[192:195], v[92:95]
buffer_load_dwordx4 v249, s[16:19], s51 offen offset:1024 nt lds
v_mfma_f32_16x16x32_bf16 a[120:123], v[160:163], v[192:195], a[120:123]
v_mfma_f32_16x16x32_bf16 a[148:151], v[164:167], v[192:195], a[148:151]
buffer_load_dwordx4 v248, s[16:19], s51 offen offset:2048 nt lds
v_mfma_f32_16x16x32_bf16 a[176:179], v[168:171], v[192:195], a[176:179]
v_mfma_f32_16x16x32_bf16 a[204:207], v[172:175], v[192:195], a[204:207]
buffer_load_dwordx4 v249, s[16:19], s51 offen offset:3072 nt lds
v_mfma_f32_16x16x32_bf16 v[184:187], v[112:115], a[80:83], v[220:223]
v_exp_f32 v176, v176
v_mfma_f32_16x16x32_bf16 v[188:191], v[128:131], a[80:83], v[220:223]
v_exp_f32 v177, v177
v_mfma_f32_16x16x32_bf16 v[184:187], v[116:119], a[84:87], v[184:187]
v_exp_f32 v178, v178
v_mfma_f32_16x16x32_bf16 v[188:191], v[132:135], a[84:87], v[188:191]
v_exp_f32 v179, v179
v_mfma_f32_16x16x32_bf16 v[184:187], v[120:123], a[88:91], v[184:187]
v_exp_f32 v180, v180
v_mfma_f32_16x16x32_bf16 v[188:191], v[136:139], a[88:91], v[188:191]
v_exp_f32 v181, v181
v_mfma_f32_16x16x32_bf16 v[184:187], v[124:127], a[92:95], v[184:187]
v_exp_f32 v182, v182
v_mfma_f32_16x16x32_bf16 v[188:191], v[140:143], a[92:95], v[188:191]
v_exp_f32 v183, v183
v_mfma_f32_16x16x32_bf16 a[236:239], v[228:231], v[196:199], a[236:239]
v_cvt_pk_bf16_f32 v192, v176, v177
v_cvt_pk_bf16_f32 v193, v178, v179
v_mfma_f32_16x16x32_bf16 v[12:15], v[144:147], v[196:199], v[12:15]
v_cvt_pk_bf16_f32 v194, v180, v181
v_cvt_pk_bf16_f32 v195, v182, v183
v_mfma_f32_16x16x32_bf16 v[40:43], v[148:151], v[196:199], v[40:43]
v_mfma_f32_16x16x32_bf16 v[68:71], v[152:155], v[196:199], v[68:71]
v_mfma_f32_16x16x32_bf16 v[96:99], v[156:159], v[196:199], v[96:99]
v_mfma_f32_16x16x32_bf16 a[124:127], v[160:163], v[196:199], a[124:127]
v_mfma_f32_16x16x32_bf16 a[152:155], v[164:167], v[196:199], a[152:155]
v_mfma_f32_16x16x32_bf16 a[180:183], v[168:171], v[196:199], a[180:183]
v_mfma_f32_16x16x32_bf16 a[208:211], v[172:175], v[196:199], a[208:211]
s_waitcnt vmcnt(24)
v_mfma_f32_16x16x32_bf16 v[176:179], v[112:115], a[96:99], v[224:227]
ds_read_b128 v[112:115], v232 offset:16384
v_mfma_f32_16x16x32_bf16 v[180:183], v[128:131], a[96:99], v[224:227]
ds_read_b128 v[128:131], v232 offset:20480
v_mfma_f32_16x16x32_bf16 v[176:179], v[116:119], a[100:103], v[176:179]
ds_read_b128 v[116:119], v233 offset:16384
v_mfma_f32_16x16x32_bf16 v[180:183], v[132:135], a[100:103], v[180:183]
ds_read_b128 v[132:135], v233 offset:20480
v_mfma_f32_16x16x32_bf16 v[176:179], v[120:123], a[104:107], v[176:179]
ds_read_b128 v[120:123], v234 offset:16384
v_mfma_f32_16x16x32_bf16 v[180:183], v[136:139], a[104:107], v[180:183]
ds_read_b128 v[136:139], v234 offset:20480
v_mfma_f32_16x16x32_bf16 v[176:179], v[124:127], a[108:111], v[176:179]
ds_read_b128 v[124:127], v235 offset:16384
v_mfma_f32_16x16x32_bf16 v[180:183], v[140:143], a[108:111], v[180:183]
ds_read_b128 v[140:143], v235 offset:20480
v_exp_f32 v184, v184
v_mfma_f32_16x16x32_bf16 a[240:243], v[228:231], v[192:195], a[240:243]
v_exp_f32 v185, v185
v_mfma_f32_16x16x32_bf16 v[16:19], v[144:147], v[192:195], v[16:19]
v_exp_f32 v186, v186
v_mfma_f32_16x16x32_bf16 v[44:47], v[148:151], v[192:195], v[44:47]
v_exp_f32 v187, v187
v_mfma_f32_16x16x32_bf16 v[72:75], v[152:155], v[192:195], v[72:75]
v_exp_f32 v188, v188
v_mfma_f32_16x16x32_bf16 v[100:103], v[156:159], v[192:195], v[100:103]
v_exp_f32 v189, v189
v_mfma_f32_16x16x32_bf16 a[128:131], v[160:163], v[192:195], a[128:131]
v_exp_f32 v190, v190
v_mfma_f32_16x16x32_bf16 a[156:159], v[164:167], v[192:195], a[156:159]
v_exp_f32 v191, v191
v_mfma_f32_16x16x32_bf16 a[184:187], v[168:171], v[192:195], a[184:187]
v_cvt_pk_bf16_f32 v196, v184, v185
v_cvt_pk_bf16_f32 v197, v186, v187
v_mfma_f32_16x16x32_bf16 a[212:215], v[172:175], v[192:195], a[212:215]
v_cvt_pk_bf16_f32 v198, v188, v189
v_cvt_pk_bf16_f32 v199, v190, v191
s_waitcnt lgkmcnt(0)
v_mfma_f32_16x16x32_bf16 v[184:187], v[112:115], a[0:3], v[200:203]
v_exp_f32 v176, v176
v_mfma_f32_16x16x32_bf16 v[188:191], v[128:131], a[0:3], v[200:203]
v_exp_f32 v177, v177
v_mfma_f32_16x16x32_bf16 v[184:187], v[116:119], a[4:7], v[184:187]
v_exp_f32 v178, v178
v_mfma_f32_16x16x32_bf16 v[188:191], v[132:135], a[4:7], v[188:191]
v_exp_f32 v179, v179
v_mfma_f32_16x16x32_bf16 v[184:187], v[120:123], a[8:11], v[184:187]
v_exp_f32 v180, v180
v_mfma_f32_16x16x32_bf16 v[188:191], v[136:139], a[8:11], v[188:191]
v_exp_f32 v181, v181
v_mfma_f32_16x16x32_bf16 v[184:187], v[124:127], a[12:15], v[184:187]
v_exp_f32 v182, v182
v_mfma_f32_16x16x32_bf16 v[188:191], v[140:143], a[12:15], v[188:191]
v_exp_f32 v183, v183
v_mfma_f32_16x16x32_bf16 a[244:247], v[228:231], v[196:199], a[244:247]
v_cvt_pk_bf16_f32 v192, v176, v177
v_cvt_pk_bf16_f32 v193, v178, v179
v_mfma_f32_16x16x32_bf16 v[20:23], v[144:147], v[196:199], v[20:23]
v_cvt_pk_bf16_f32 v194, v180, v181
v_cvt_pk_bf16_f32 v195, v182, v183
v_mfma_f32_16x16x32_bf16 v[48:51], v[148:151], v[196:199], v[48:51]
s_add_u32 m0, s50, 16384
s_add_u32 s51, s56, 24576
s_xor_b32 s51, s51, s33
buffer_load_dwordx4 v244, s[12:15], s51 offen offset:0 nt lds
v_mfma_f32_16x16x32_bf16 v[76:79], v[152:155], v[196:199], v[76:79]
v_mfma_f32_16x16x32_bf16 v[104:107], v[156:159], v[196:199], v[104:107]
buffer_load_dwordx4 v245, s[12:15], s51 offen offset:1024 nt lds
v_mfma_f32_16x16x32_bf16 a[132:135], v[160:163], v[196:199], a[132:135]
v_mfma_f32_16x16x32_bf16 a[160:163], v[164:167], v[196:199], a[160:163]
buffer_load_dwordx4 v246, s[12:15], s51 offen offset:2048 nt lds
v_mfma_f32_16x16x32_bf16 a[188:191], v[168:171], v[196:199], a[188:191]
v_mfma_f32_16x16x32_bf16 a[216:219], v[172:175], v[196:199], a[216:219]
buffer_load_dwordx4 v247, s[12:15], s51 offen offset:3072 nt lds
v_mfma_f32_16x16x32_bf16 v[176:179], v[112:115], a[16:19], v[204:207]
v_exp_f32 v184, v184
v_mfma_f32_16x16x32_bf16 v[180:183], v[128:131], a[16:19], v[204:207]
v_exp_f32 v185, v185
v_mfma_f32_16x16x32_bf16 v[176:179], v[116:119], a[20:23], v[176:179]
v_exp_f32 v186, v186
v_mfma_f32_16x16x32_bf16 v[180:183], v[132:135], a[20:23], v[180:183]
v_exp_f32 v187, v187
v_mfma_f32_16x16x32_bf16 v[176:179], v[120:123], a[24:27], v[176:179]
v_exp_f32 v188, v188
v_mfma_f32_16x16x32_bf16 v[180:183], v[136:139], a[24:27], v[180:183]
v_exp_f32 v189, v189
v_mfma_f32_16x16x32_bf16 v[176:179], v[124:127], a[28:31], v[176:179]
v_exp_f32 v190, v190
v_mfma_f32_16x16x32_bf16 v[180:183], v[140:143], a[28:31], v[180:183]
v_exp_f32 v191, v191
v_mfma_f32_16x16x32_bf16 a[248:251], v[228:231], v[192:195], a[248:251]
v_cvt_pk_bf16_f32 v196, v184, v185
v_cvt_pk_bf16_f32 v197, v186, v187
v_cvt_pk_bf16_f32 v198, v188, v189
v_cvt_pk_bf16_f32 v199, v190, v191
s_waitcnt vmcnt(20)
v_mfma_f32_16x16x32_bf16 v[24:27], v[144:147], v[192:195], v[24:27]
ds_read_b64_tr_b16 v[144:145], v236 offset:16384
ds_read_b64_tr_b16 v[146:147], v236 offset:20480
v_mfma_f32_16x16x32_bf16 v[52:55], v[148:151], v[192:195], v[52:55]
ds_read_b64_tr_b16 v[148:149], v237 offset:16384
ds_read_b64_tr_b16 v[150:151], v237 offset:20480
v_mfma_f32_16x16x32_bf16 v[80:83], v[152:155], v[192:195], v[80:83]
ds_read_b64_tr_b16 v[152:153], v238 offset:16384
ds_read_b64_tr_b16 v[154:155], v238 offset:20480
v_mfma_f32_16x16x32_bf16 v[108:111], v[156:159], v[192:195], v[108:111]
ds_read_b64_tr_b16 v[156:157], v239 offset:16384
ds_read_b64_tr_b16 v[158:159], v239 offset:20480
v_mfma_f32_16x16x32_bf16 a[136:139], v[160:163], v[192:195], a[136:139]
ds_read_b64_tr_b16 v[160:161], v240 offset:16384
ds_read_b64_tr_b16 v[162:163], v240 offset:20480
v_mfma_f32_16x16x32_bf16 a[164:167], v[164:167], v[192:195], a[164:167]
ds_read_b64_tr_b16 v[164:165], v241 offset:16384
ds_read_b64_tr_b16 v[166:167], v241 offset:20480
v_mfma_f32_16x16x32_bf16 a[192:195], v[168:171], v[192:195], a[192:195]
ds_read_b64_tr_b16 v[168:169], v242 offset:16384
ds_read_b64_tr_b16 v[170:171], v242 offset:20480
v_mfma_f32_16x16x32_bf16 a[220:223], v[172:175], v[192:195], a[220:223]
ds_read_b64_tr_b16 v[172:173], v243 offset:16384
ds_read_b64_tr_b16 v[174:175], v243 offset:20480
v_mfma_f32_16x16x32_bf16 v[184:187], v[112:115], a[32:35], v[208:211]
v_exp_f32 v176, v176
v_mfma_f32_16x16x32_bf16 v[188:191], v[128:131], a[32:35], v[208:211]
v_exp_f32 v177, v177
v_mfma_f32_16x16x32_bf16 v[184:187], v[116:119], a[36:39], v[184:187]
v_exp_f32 v178, v178
v_mfma_f32_16x16x32_bf16 v[188:191], v[132:135], a[36:39], v[188:191]
v_exp_f32 v179, v179
v_mfma_f32_16x16x32_bf16 v[184:187], v[120:123], a[40:43], v[184:187]
v_exp_f32 v180, v180
v_mfma_f32_16x16x32_bf16 v[188:191], v[136:139], a[40:43], v[188:191]
v_exp_f32 v181, v181
v_mfma_f32_16x16x32_bf16 v[184:187], v[124:127], a[44:47], v[184:187]
v_exp_f32 v182, v182
v_mfma_f32_16x16x32_bf16 v[188:191], v[140:143], a[44:47], v[188:191]
v_exp_f32 v183, v183
s_waitcnt lgkmcnt(0)
v_mfma_f32_16x16x32_bf16 a[224:227], v[228:231], v[196:199], a[224:227]
v_cvt_pk_bf16_f32 v192, v176, v177
v_cvt_pk_bf16_f32 v193, v178, v179
v_mfma_f32_16x16x32_bf16 v[0:3], v[144:147], v[196:199], v[0:3]
v_cvt_pk_bf16_f32 v194, v180, v181
v_cvt_pk_bf16_f32 v195, v182, v183
v_mfma_f32_16x16x32_bf16 v[28:31], v[148:151], v[196:199], v[28:31]
s_add_u32 m0, s50, 20480
s_add_u32 s51, s56, 28672
s_xor_b32 s51, s51, s33
buffer_load_dwordx4 v244, s[12:15], s51 offen offset:0 nt lds
v_mfma_f32_16x16x32_bf16 v[56:59], v[152:155], v[196:199], v[56:59]
v_mfma_f32_16x16x32_bf16 v[84:87], v[156:159], v[196:199], v[84:87]
buffer_load_dwordx4 v245, s[12:15], s51 offen offset:1024 nt lds
v_mfma_f32_16x16x32_bf16 a[112:115], v[160:163], v[196:199], a[112:115]
v_mfma_f32_16x16x32_bf16 a[140:143], v[164:167], v[196:199], a[140:143]
buffer_load_dwordx4 v246, s[12:15], s51 offen offset:2048 nt lds
v_mfma_f32_16x16x32_bf16 a[168:171], v[168:171], v[196:199], a[168:171]
v_mfma_f32_16x16x32_bf16 a[196:199], v[172:175], v[196:199], a[196:199]
buffer_load_dwordx4 v247, s[12:15], s51 offen offset:3072 nt lds
v_mfma_f32_16x16x32_bf16 v[176:179], v[112:115], a[48:51], v[212:215]
v_exp_f32 v184, v184
v_mfma_f32_16x16x32_bf16 v[180:183], v[128:131], a[48:51], v[212:215]
v_exp_f32 v185, v185
v_mfma_f32_16x16x32_bf16 v[176:179], v[116:119], a[52:55], v[176:179]
v_exp_f32 v186, v186
v_mfma_f32_16x16x32_bf16 v[180:183], v[132:135], a[52:55], v[180:183]
v_exp_f32 v187, v187
v_mfma_f32_16x16x32_bf16 v[176:179], v[120:123], a[56:59], v[176:179]
v_exp_f32 v188, v188
v_mfma_f32_16x16x32_bf16 v[180:183], v[136:139], a[56:59], v[180:183]
v_exp_f32 v189, v189
v_mfma_f32_16x16x32_bf16 v[176:179], v[124:127], a[60:63], v[176:179]
v_exp_f32 v190, v190
v_mfma_f32_16x16x32_bf16 v[180:183], v[140:143], a[60:63], v[180:183]
v_exp_f32 v191, v191
v_mfma_f32_16x16x32_bf16 a[228:231], v[228:231], v[192:195], a[228:231]
v_cvt_pk_bf16_f32 v196, v184, v185
v_cvt_pk_bf16_f32 v197, v186, v187
v_mfma_f32_16x16x32_bf16 v[4:7], v[144:147], v[192:195], v[4:7]
v_cvt_pk_bf16_f32 v198, v188, v189
v_cvt_pk_bf16_f32 v199, v190, v191
v_mfma_f32_16x16x32_bf16 v[32:35], v[148:151], v[192:195], v[32:35]
s_add_u32 m0, s50, 24576
s_add_u32 s51, s56, 24576
s_xor_b32 s51, s51, s33
buffer_load_dwordx4 v248, s[16:19], s51 offen offset:0 nt lds
v_mfma_f32_16x16x32_bf16 v[60:63], v[152:155], v[192:195], v[60:63]
v_mfma_f32_16x16x32_bf16 v[88:91], v[156:159], v[192:195], v[88:91]
buffer_load_dwordx4 v249, s[16:19], s51 offen offset:1024 nt lds
v_mfma_f32_16x16x32_bf16 a[116:119], v[160:163], v[192:195], a[116:119]
v_mfma_f32_16x16x32_bf16 a[144:147], v[164:167], v[192:195], a[144:147]
buffer_load_dwordx4 v248, s[16:19], s51 offen offset:2048 nt lds
v_mfma_f32_16x16x32_bf16 a[172:175], v[168:171], v[192:195], a[172:175]
v_mfma_f32_16x16x32_bf16 a[200:203], v[172:175], v[192:195], a[200:203]
buffer_load_dwordx4 v249, s[16:19], s51 offen offset:3072 nt lds
v_mfma_f32_16x16x32_bf16 v[184:187], v[112:115], a[64:67], v[216:219]
v_exp_f32 v176, v176
v_mfma_f32_16x16x32_bf16 v[188:191], v[128:131], a[64:67], v[216:219]
v_exp_f32 v177, v177
v_mfma_f32_16x16x32_bf16 v[184:187], v[116:119], a[68:71], v[184:187]
v_exp_f32 v178, v178
v_mfma_f32_16x16x32_bf16 v[188:191], v[132:135], a[68:71], v[188:191]
v_exp_f32 v179, v179
v_mfma_f32_16x16x32_bf16 v[184:187], v[120:123], a[72:75], v[184:187]
v_exp_f32 v180, v180
v_mfma_f32_16x16x32_bf16 v[188:191], v[136:139], a[72:75], v[188:191]
v_exp_f32 v181, v181
v_mfma_f32_16x16x32_bf16 v[184:187], v[124:127], a[76:79], v[184:187]
v_exp_f32 v182, v182
v_mfma_f32_16x16x32_bf16 v[188:191], v[140:143], a[76:79], v[188:191]
v_exp_f32 v183, v183
v_mfma_f32_16x16x32_bf16 a[232:235], v[228:231], v[196:199], a[232:235]
v_cvt_pk_bf16_f32 v192, v176, v177
v_cvt_pk_bf16_f32 v193, v178, v179
v_mfma_f32_16x16x32_bf16 v[8:11], v[144:147], v[196:199], v[8:11]
v_cvt_pk_bf16_f32 v194, v180, v181
v_cvt_pk_bf16_f32 v195, v182, v183
v_mfma_f32_16x16x32_bf16 v[36:39], v[148:151], v[196:199], v[36:39]
s_add_u32 m0, s50, 28672
s_add_u32 s51, s56, 28672
s_xor_b32 s51, s51, s33
buffer_load_dwordx4 v248, s[16:19], s51 offen offset:0 nt lds
v_mfma_f32_16x16x32_bf16 v[64:67], v[152:155], v[196:199], v[64:67]
v_mfma_f32_16x16x32_bf16 v[92:95], v[156:159], v[196:199], v[92:95]
buffer_load_dwordx4 v249, s[16:19], s51 offen offset:1024 nt lds
v_mfma_f32_16x16x32_bf16 a[120:123], v[160:163], v[196:199], a[120:123]
v_mfma_f32_16x16x32_bf16 a[148:151], v[164:167], v[196:199], a[148:151]
buffer_load_dwordx4 v248, s[16:19], s51 offen offset:2048 nt lds
v_mfma_f32_16x16x32_bf16 a[176:179], v[168:171], v[196:199], a[176:179]
v_mfma_f32_16x16x32_bf16 a[204:207], v[172:175], v[196:199], a[204:207]
buffer_load_dwordx4 v249, s[16:19], s51 offen offset:3072 nt lds
v_mfma_f32_16x16x32_bf16 v[176:179], v[112:115], a[80:83], v[220:223]
v_exp_f32 v184, v184
v_mfma_f32_16x16x32_bf16 v[180:183], v[128:131], a[80:83], v[220:223]
v_exp_f32 v185, v185
v_mfma_f32_16x16x32_bf16 v[176:179], v[116:119], a[84:87], v[176:179]
v_exp_f32 v186, v186
v_mfma_f32_16x16x32_bf16 v[180:183], v[132:135], a[84:87], v[180:183]
v_exp_f32 v187, v187
v_mfma_f32_16x16x32_bf16 v[176:179], v[120:123], a[88:91], v[176:179]
v_exp_f32 v188, v188
v_mfma_f32_16x16x32_bf16 v[180:183], v[136:139], a[88:91], v[180:183]
v_exp_f32 v189, v189
v_mfma_f32_16x16x32_bf16 v[176:179], v[124:127], a[92:95], v[176:179]
v_exp_f32 v190, v190
v_mfma_f32_16x16x32_bf16 v[180:183], v[140:143], a[92:95], v[180:183]
v_exp_f32 v191, v191
v_mfma_f32_16x16x32_bf16 a[236:239], v[228:231], v[192:195], a[236:239]
v_cvt_pk_bf16_f32 v196, v184, v185
v_cvt_pk_bf16_f32 v197, v186, v187
v_mfma_f32_16x16x32_bf16 v[12:15], v[144:147], v[192:195], v[12:15]
v_cvt_pk_bf16_f32 v198, v188, v189
v_cvt_pk_bf16_f32 v199, v190, v191
v_mfma_f32_16x16x32_bf16 v[40:43], v[148:151], v[192:195], v[40:43]
v_mfma_f32_16x16x32_bf16 v[68:71], v[152:155], v[192:195], v[68:71]
v_mfma_f32_16x16x32_bf16 v[96:99], v[156:159], v[192:195], v[96:99]
v_mfma_f32_16x16x32_bf16 a[124:127], v[160:163], v[192:195], a[124:127]
v_mfma_f32_16x16x32_bf16 a[152:155], v[164:167], v[192:195], a[152:155]
v_mfma_f32_16x16x32_bf16 a[180:183], v[168:171], v[192:195], a[180:183]
v_mfma_f32_16x16x32_bf16 a[208:211], v[172:175], v[192:195], a[208:211]
s_waitcnt vmcnt(24)
v_mfma_f32_16x16x32_bf16 v[184:187], v[112:115], a[96:99], v[224:227]
ds_read_b128 v[112:115], v232 offset:0
v_mfma_f32_16x16x32_bf16 v[188:191], v[128:131], a[96:99], v[224:227]
ds_read_b128 v[128:131], v232 offset:4096
v_mfma_f32_16x16x32_bf16 v[184:187], v[116:119], a[100:103], v[184:187]
ds_read_b128 v[116:119], v233 offset:0
v_mfma_f32_16x16x32_bf16 v[188:191], v[132:135], a[100:103], v[188:191]
ds_read_b128 v[132:135], v233 offset:4096
v_mfma_f32_16x16x32_bf16 v[184:187], v[120:123], a[104:107], v[184:187]
ds_read_b128 v[120:123], v234 offset:0
v_mfma_f32_16x16x32_bf16 v[188:191], v[136:139], a[104:107], v[188:191]
ds_read_b128 v[136:139], v234 offset:4096
v_mfma_f32_16x16x32_bf16 v[184:187], v[124:127], a[108:111], v[184:187]
ds_read_b128 v[124:127], v235 offset:0
v_mfma_f32_16x16x32_bf16 v[188:191], v[140:143], a[108:111], v[188:191]
ds_read_b128 v[140:143], v235 offset:4096
v_exp_f32 v176, v176
v_mfma_f32_16x16x32_bf16 a[240:243], v[228:231], v[196:199], a[240:243]
v_exp_f32 v177, v177
v_mfma_f32_16x16x32_bf16 v[16:19], v[144:147], v[196:199], v[16:19]
v_exp_f32 v178, v178
v_mfma_f32_16x16x32_bf16 v[44:47], v[148:151], v[196:199], v[44:47]
v_exp_f32 v179, v179
v_mfma_f32_16x16x32_bf16 v[72:75], v[152:155], v[196:199], v[72:75]
v_exp_f32 v180, v180
v_mfma_f32_16x16x32_bf16 v[100:103], v[156:159], v[196:199], v[100:103]
v_exp_f32 v181, v181
v_mfma_f32_16x16x32_bf16 a[128:131], v[160:163], v[196:199], a[128:131]
v_exp_f32 v182, v182
v_mfma_f32_16x16x32_bf16 a[156:159], v[164:167], v[196:199], a[156:159]
v_exp_f32 v183, v183
v_mfma_f32_16x16x32_bf16 a[184:187], v[168:171], v[196:199], a[184:187]
v_cvt_pk_bf16_f32 v192, v176, v177
v_cvt_pk_bf16_f32 v193, v178, v179
v_mfma_f32_16x16x32_bf16 a[212:215], v[172:175], v[196:199], a[212:215]
v_cvt_pk_bf16_f32 v194, v180, v181
v_cvt_pk_bf16_f32 v195, v182, v183
s_waitcnt lgkmcnt(0)
v_mfma_f32_16x16x32_bf16 v[176:179], v[112:115], a[0:3], v[200:203]
v_exp_f32 v184, v184
v_mfma_f32_16x16x32_bf16 v[180:183], v[128:131], a[0:3], v[200:203]
v_exp_f32 v185, v185
v_mfma_f32_16x16x32_bf16 v[176:179], v[116:119], a[4:7], v[176:179]
v_exp_f32 v186, v186
v_mfma_f32_16x16x32_bf16 v[180:183], v[132:135], a[4:7], v[180:183]
v_exp_f32 v187, v187
v_mfma_f32_16x16x32_bf16 v[176:179], v[120:123], a[8:11], v[176:179]
v_exp_f32 v188, v188
v_mfma_f32_16x16x32_bf16 v[180:183], v[136:139], a[8:11], v[180:183]
v_exp_f32 v189, v189
v_mfma_f32_16x16x32_bf16 v[176:179], v[124:127], a[12:15], v[176:179]
v_exp_f32 v190, v190
v_mfma_f32_16x16x32_bf16 v[180:183], v[140:143], a[12:15], v[180:183]
v_exp_f32 v191, v191
v_mfma_f32_16x16x32_bf16 a[244:247], v[228:231], v[192:195], a[244:247]
v_cvt_pk_bf16_f32 v196, v184, v185
v_cvt_pk_bf16_f32 v197, v186, v187
v_mfma_f32_16x16x32_bf16 v[20:23], v[144:147], v[192:195], v[20:23]
v_cvt_pk_bf16_f32 v198, v188, v189
v_cvt_pk_bf16_f32 v199, v190, v191
v_mfma_f32_16x16x32_bf16 v[48:51], v[148:151], v[192:195], v[48:51]
s_add_u32 m0, s50, 0
s_add_u32 s51, s56, 32768
s_xor_b32 s51, s51, s33
buffer_load_dwordx4 v244, s[12:15], s51 offen offset:0 nt lds
v_mfma_f32_16x16x32_bf16 v[76:79], v[152:155], v[192:195], v[76:79]
v_mfma_f32_16x16x32_bf16 v[104:107], v[156:159], v[192:195], v[104:107]
buffer_load_dwordx4 v245, s[12:15], s51 offen offset:1024 nt lds
v_mfma_f32_16x16x32_bf16 a[132:135], v[160:163], v[192:195], a[132:135]
v_mfma_f32_16x16x32_bf16 a[160:163], v[164:167], v[192:195], a[160:163]
buffer_load_dwordx4 v246, s[12:15], s51 offen offset:2048 nt lds
v_mfma_f32_16x16x32_bf16 a[188:191], v[168:171], v[192:195], a[188:191]
s_add_u32 s56, s56, 16384
s_cmp_lt_u32 s56, 114688
v_mfma_f32_16x16x32_bf16 a[216:219], v[172:175], v[192:195], a[216:219]
buffer_load_dwordx4 v247, s[12:15], s51 offen offset:3072 nt lds
s_cbranch_scc1 L1_loop1
L1_post:
v_mfma_f32_16x16x32_bf16 v[184:187], v[112:115], a[16:19], v[204:207]
v_exp_f32 v176, v176
v_mfma_f32_16x16x32_bf16 v[188:191], v[128:131], a[16:19], v[204:207]
v_exp_f32 v177, v177
v_mfma_f32_16x16x32_bf16 v[184:187], v[116:119], a[20:23], v[184:187]
v_exp_f32 v178, v178
v_mfma_f32_16x16x32_bf16 v[188:191], v[132:135], a[20:23], v[188:191]
v_exp_f32 v179, v179
v_mfma_f32_16x16x32_bf16 v[184:187], v[120:123], a[24:27], v[184:187]
v_exp_f32 v180, v180
v_mfma_f32_16x16x32_bf16 v[188:191], v[136:139], a[24:27], v[188:191]
v_exp_f32 v181, v181
v_mfma_f32_16x16x32_bf16 v[184:187], v[124:127], a[28:31], v[184:187]
v_exp_f32 v182, v182
v_mfma_f32_16x16x32_bf16 v[188:191], v[140:143], a[28:31], v[188:191]
v_exp_f32 v183, v183
v_mfma_f32_16x16x32_bf16 a[248:251], v[228:231], v[196:199], a[248:251]
v_cvt_pk_bf16_f32 v192, v176, v177
v_cvt_pk_bf16_f32 v193, v178, v179
v_cvt_pk_bf16_f32 v194, v180, v181
v_cvt_pk_bf16_f32 v195, v182, v183
s_waitcnt vmcnt(20)
v_mfma_f32_16x16x32_bf16 v[24:27], v[144:147], v[196:199], v[24:27]
ds_read_b64_tr_b16 v[144:145], v236 offset:0
ds_read_b64_tr_b16 v[146:147], v236 offset:4096
v_mfma_f32_16x16x32_bf16 v[52:55], v[148:151], v[196:199], v[52:55]
ds_read_b64_tr_b16 v[148:149], v237 offset:0
ds_read_b64_tr_b16 v[150:151], v237 offset:4096
v_mfma_f32_16x16x32_bf16 v[80:83], v[152:155], v[196:199], v[80:83]
ds_read_b64_tr_b16 v[152:153], v238 offset:0
ds_read_b64_tr_b16 v[154:155], v238 offset:4096
v_mfma_f32_16x16x32_bf16 v[108:111], v[156:159], v[196:199], v[108:111]
ds_read_b64_tr_b16 v[156:157], v239 offset:0
ds_read_b64_tr_b16 v[158:159], v239 offset:4096
v_mfma_f32_16x16x32_bf16 a[136:139], v[160:163], v[196:199], a[136:139]
ds_read_b64_tr_b16 v[160:161], v240 offset:0
ds_read_b64_tr_b16 v[162:163], v240 offset:4096
v_mfma_f32_16x16x32_bf16 a[164:167], v[164:167], v[196:199], a[164:167]
ds_read_b64_tr_b16 v[164:165], v241 offset:0
ds_read_b64_tr_b16 v[166:167], v241 offset:4096
v_mfma_f32_16x16x32_bf16 a[192:195], v[168:171], v[196:199], a[192:195]
ds_read_b64_tr_b16 v[168:169], v242 offset:0
ds_read_b64_tr_b16 v[170:171], v242 offset:4096
v_mfma_f32_16x16x32_bf16 a[220:223], v[172:175], v[196:199], a[220:223]
ds_read_b64_tr_b16 v[172:173], v243 offset:0
ds_read_b64_tr_b16 v[174:175], v243 offset:4096
v_mfma_f32_16x16x32_bf16 v[176:179], v[112:115], a[32:35], v[208:211]
v_exp_f32 v184, v184
v_mfma_f32_16x16x32_bf16 v[180:183], v[128:131], a[32:35], v[208:211]
v_exp_f32 v185, v185
v_mfma_f32_16x16x32_bf16 v[176:179], v[116:119], a[36:39], v[176:179]
v_exp_f32 v186, v186
v_mfma_f32_16x16x32_bf16 v[180:183], v[132:135], a[36:39], v[180:183]
v_exp_f32 v187, v187
v_mfma_f32_16x16x32_bf16 v[176:179], v[120:123], a[40:43], v[176:179]
v_exp_f32 v188, v188
v_mfma_f32_16x16x32_bf16 v[180:183], v[136:139], a[40:43], v[180:183]
v_exp_f32 v189, v189
v_mfma_f32_16x16x32_bf16 v[176:179], v[124:127], a[44:47], v[176:179]
v_exp_f32 v190, v190
v_mfma_f32_16x16x32_bf16 v[180:183], v[140:143], a[44:47], v[180:183]
v_exp_f32 v191, v191
s_waitcnt lgkmcnt(0)
v_mfma_f32_16x16x32_bf16 a[224:227], v[228:231], v[192:195], a[224:227]
v_cvt_pk_bf16_f32 v196, v184, v185
v_cvt_pk_bf16_f32 v197, v186, v187
v_mfma_f32_16x16x32_bf16 v[0:3], v[144:147], v[192:195], v[0:3]
v_cvt_pk_bf16_f32 v198, v188, v189
v_cvt_pk_bf16_f32 v199, v190, v191
v_mfma_f32_16x16x32_bf16 v[28:31], v[148:151], v[192:195], v[28:31]
s_add_u32 m0, s99, 0
s_add_u32 s51, s96, 0
buffer_load_dwordx4 v255, s[92:95], s51 offen offset:0  lds
v_mfma_f32_16x16x32_bf16 v[56:59], v[152:155], v[192:195], v[56:59]
v_mfma_f32_16x16x32_bf16 v[84:87], v[156:159], v[192:195], v[84:87]
s_add_u32 s51, s96, 8192
buffer_load_dwordx4 v255, s[92:95], s51 offen offset:1024  lds
v_mfma_f32_16x16x32_bf16 a[112:115], v[160:163], v[192:195], a[112:115]
v_mfma_f32_16x16x32_bf16 a[140:143], v[164:167], v[192:195], a[140:143]
s_add_u32 s51, s96, 16384
buffer_load_dwordx4 v255, s[92:95], s51 offen offset:2048  lds
v_mfma_f32_16x16x32_bf16 a[168:171], v[168:171], v[192:195], a[168:171]
v_mfma_f32_16x16x32_bf16 a[196:199], v[172:175], v[192:195], a[196:199]
s_add_u32 s51, s96, 24576
buffer_load_dwordx4 v255, s[92:95], s51 offen offset:3072  lds
v_mfma_f32_16x16x32_bf16 v[184:187], v[112:115], a[48:51], v[212:215]
v_exp_f32 v176, v176
v_mfma_f32_16x16x32_bf16 v[188:191], v[128:131], a[48:51], v[212:215]
v_exp_f32 v177, v177
v_mfma_f32_16x16x32_bf16 v[184:187], v[116:119], a[52:55], v[184:187]
v_exp_f32 v178, v178
v_mfma_f32_16x16x32_bf16 v[188:191], v[132:135], a[52:55], v[188:191]
v_exp_f32 v179, v179
v_mfma_f32_16x16x32_bf16 v[184:187], v[120:123], a[56:59], v[184:187]
v_exp_f32 v180, v180
v_mfma_f32_16x16x32_bf16 v[188:191], v[136:139], a[56:59], v[188:191]
v_exp_f32 v181, v181
v_mfma_f32_16x16x32_bf16 v[184:187], v[124:127], a[60:63], v[184:187]
v_exp_f32 v182, v182
v_mfma_f32_16x16x32_bf16 v[188:191], v[140:143], a[60:63], v[188:191]
v_exp_f32 v183, v183
v_mfma_f32_16x16x32_bf16 a[228:231], v[228:231], v[196:199], a[228:231]
v_cvt_pk_bf16_f32 v192, v176, v177
v_cvt_pk_bf16_f32 v193, v178, v179
v_mfma_f32_16x16x32_bf16 v[4:7], v[144:147], v[196:199], v[4:7]
v_cvt_pk_bf16_f32 v194, v180, v181
v_cvt_pk_bf16_f32 v195, v182, v183
v_mfma_f32_16x16x32_bf16 v[32:35], v[148:151], v[196:199], v[32:35]
s_add_u32 m0, s99, 4096
s_add_u32 s51, s96, 36864
buffer_load_dwordx4 v255, s[92:95], s51 offen offset:0  lds
v_mfma_f32_16x16x32_bf16 v[60:63], v[152:155], v[196:199], v[60:63]
v_mfma_f32_16x16x32_bf16 v[88:91], v[156:159], v[196:199], v[88:91]
s_add_u32 s51, s96, 45056
buffer_load_dwordx4 v255, s[92:95], s51 offen offset:1024  lds
v_mfma_f32_16x16x32_bf16 a[116:119], v[160:163], v[196:199], a[116:119]
v_mfma_f32_16x16x32_bf16 a[144:147], v[164:167], v[196:199], a[144:147]
s_add_u32 s51, s96, 53248
buffer_load_dwordx4 v255, s[92:95], s51 offen offset:2048  lds
v_mfma_f32_16x16x32_bf16 a[172:175], v[168:171], v[196:199], a[172:175]
v_mfma_f32_16x16x32_bf16 a[200:203], v[172:175], v[196:199], a[200:203]
s_add_u32 s51, s96, 61440
buffer_load_dwordx4 v255, s[92:95], s51 offen offset:3072  lds
v_mfma_f32_16x16x32_bf16 v[176:179], v[112:115], a[64:67], v[216:219]
v_exp_f32 v184, v184
v_mfma_f32_16x16x32_bf16 v[180:183], v[128:131], a[64:67], v[216:219]
v_exp_f32 v185, v185
v_mfma_f32_16x16x32_bf16 v[176:179], v[116:119], a[68:71], v[176:179]
v_exp_f32 v186, v186
v_mfma_f32_16x16x32_bf16 v[180:183], v[132:135], a[68:71], v[180:183]
v_exp_f32 v187, v187
v_mfma_f32_16x16x32_bf16 v[176:179], v[120:123], a[72:75], v[176:179]
v_exp_f32 v188, v188
v_mfma_f32_16x16x32_bf16 v[180:183], v[136:139], a[72:75], v[180:183]
v_exp_f32 v189, v189
v_mfma_f32_16x16x32_bf16 v[176:179], v[124:127], a[76:79], v[176:179]
v_exp_f32 v190, v190
v_mfma_f32_16x16x32_bf16 v[180:183], v[140:143], a[76:79], v[180:183]
v_exp_f32 v191, v191
v_mfma_f32_16x16x32_bf16 a[232:235], v[228:231], v[192:195], a[232:235]
v_cvt_pk_bf16_f32 v196, v184, v185
v_cvt_pk_bf16_f32 v197, v186, v187
v_mfma_f32_16x16x32_bf16 v[8:11], v[144:147], v[192:195], v[8:11]
v_cvt_pk_bf16_f32 v198, v188, v189
v_cvt_pk_bf16_f32 v199, v190, v191
v_mfma_f32_16x16x32_bf16 v[36:39], v[148:151], v[192:195], v[36:39]
s_lshl_b32 s51, s27, 2
s_add_u32 s51, s51, s24
v_mfma_f32_16x16x32_bf16 v[64:67], v[152:155], v[192:195], v[64:67]
v_mfma_f32_16x16x32_bf16 v[92:95], v[156:159], v[192:195], v[92:95]
s_mul_i32 s51, s51, 9216
v_mfma_f32_16x16x32_bf16 a[120:123], v[160:163], v[192:195], a[120:123]
v_mfma_f32_16x16x32_bf16 a[148:151], v[164:167], v[192:195], a[148:151]
buffer_load_dword v253, v255, s[92:95], s51 offen offset:1024
v_mfma_f32_16x16x32_bf16 a[176:179], v[168:171], v[192:195], a[176:179]
v_mfma_f32_16x16x32_bf16 a[204:207], v[172:175], v[192:195], a[204:207]
v_mfma_f32_16x16x32_bf16 v[184:187], v[112:115], a[80:83], v[220:223]
v_exp_f32 v176, v176
v_mfma_f32_16x16x32_bf16 v[188:191], v[128:131], a[80:83], v[220:223]
v_exp_f32 v177, v177
v_mfma_f32_16x16x32_bf16 v[184:187], v[116:119], a[84:87], v[184:187]
v_exp_f32 v178, v178
v_mfma_f32_16x16x32_bf16 v[188:191], v[132:135], a[84:87], v[188:191]
v_exp_f32 v179, v179
v_mfma_f32_16x16x32_bf16 v[184:187], v[120:123], a[88:91], v[184:187]
v_exp_f32 v180, v180
v_mfma_f32_16x16x32_bf16 v[188:191], v[136:139], a[88:91], v[188:191]
v_exp_f32 v181, v181
v_mfma_f32_16x16x32_bf16 v[184:187], v[124:127], a[92:95], v[184:187]
v_exp_f32 v182, v182
v_mfma_f32_16x16x32_bf16 v[188:191], v[140:143], a[92:95], v[188:191]
v_exp_f32 v183, v183
v_mfma_f32_16x16x32_bf16 a[236:239], v[228:231], v[196:199], a[236:239]
v_cvt_pk_bf16_f32 v192, v176, v177
v_cvt_pk_bf16_f32 v193, v178, v179
v_mfma_f32_16x16x32_bf16 v[12:15], v[144:147], v[196:199], v[12:15]
v_cvt_pk_bf16_f32 v194, v180, v181
v_cvt_pk_bf16_f32 v195, v182, v183
v_mfma_f32_16x16x32_bf16 v[40:43], v[148:151], v[196:199], v[40:43]
v_mfma_f32_16x16x32_bf16 v[68:71], v[152:155], v[196:199], v[68:71]
v_mfma_f32_16x16x32_bf16 v[96:99], v[156:159], v[196:199], v[96:99]
v_mfma_f32_16x16x32_bf16 a[124:127], v[160:163], v[196:199], a[124:127]
v_mfma_f32_16x16x32_bf16 a[152:155], v[164:167], v[196:199], a[152:155]
v_mfma_f32_16x16x32_bf16 a[180:183], v[168:171], v[196:199], a[180:183]
v_mfma_f32_16x16x32_bf16 a[208:211], v[172:175], v[196:199], a[208:211]
s_waitcnt vmcnt(21)
v_mfma_f32_16x16x32_bf16 v[176:179], v[112:115], a[96:99], v[224:227]
ds_read_b128 v[112:115], v232 offset:16384
v_mfma_f32_16x16x32_bf16 v[180:183], v[128:131], a[96:99], v[224:227]
ds_read_b128 v[128:131], v232 offset:20480
v_mfma_f32_16x16x32_bf16 v[176:179], v[116:119], a[100:103], v[176:179]
ds_read_b128 v[116:119], v233 offset:16384
v_mfma_f32_16x16x32_bf16 v[180:183], v[132:135], a[100:103], v[180:183]
ds_read_b128 v[132:135], v233 offset:20480
v_mfma_f32_16x16x32_bf16 v[176:179], v[120:123], a[104:107], v[176:179]
ds_read_b128 v[120:123], v234 offset:16384
v_mfma_f32_16x16x32_bf16 v[180:183], v[136:139], a[104:107], v[180:183]
ds_read_b128 v[136:139], v234 offset:20480
v_mfma_f32_16x16x32_bf16 v[176:179], v[124:127], a[108:111], v[176:179]
ds_read_b128 v[124:127], v235 offset:16384
v_mfma_f32_16x16x32_bf16 v[180:183], v[140:143], a[108:111], v[180:183]
ds_read_b128 v[140:143], v235 offset:20480
v_exp_f32 v184, v184
v_mfma_f32_16x16x32_bf16 a[240:243], v[228:231], v[192:195], a[240:243]
v_exp_f32 v185, v185
v_mfma_f32_16x16x32_bf16 v[16:19], v[144:147], v[192:195], v[16:19]
v_exp_f32 v186, v186
v_mfma_f32_16x16x32_bf16 v[44:47], v[148:151], v[192:195], v[44:47]
v_exp_f32 v187, v187
v_mfma_f32_16x16x32_bf16 v[72:75], v[152:155], v[192:195], v[72:75]
v_exp_f32 v188, v188
v_mfma_f32_16x16x32_bf16 v[100:103], v[156:159], v[192:195], v[100:103]
v_exp_f32 v189, v189
v_mfma_f32_16x16x32_bf16 a[128:131], v[160:163], v[192:195], a[128:131]
v_exp_f32 v190, v190
v_mfma_f32_16x16x32_bf16 a[156:159], v[164:167], v[192:195], a[156:159]
v_exp_f32 v191, v191
v_mfma_f32_16x16x32_bf16 a[184:187], v[168:171], v[192:195], a[184:187]
v_cvt_pk_bf16_f32 v196, v184, v185
v_cvt_pk_bf16_f32 v197, v186, v187
v_mfma_f32_16x16x32_bf16 a[212:215], v[172:175], v[192:195], a[212:215]
v_cvt_pk_bf16_f32 v198, v188, v189
v_cvt_pk_bf16_f32 v199, v190, v191
s_waitcnt lgkmcnt(0)
v_mfma_f32_16x16x32_bf16 v[184:187], v[112:115], a[0:3], v[200:203]
v_exp_f32 v176, v176
v_mfma_f32_16x16x32_bf16 v[188:191], v[128:131], a[0:3], v[200:203]
v_exp_f32 v177, v177
v_mfma_f32_16x16x32_bf16 v[184:187], v[116:119], a[4:7], v[184:187]
v_exp_f32 v178, v178
v_mfma_f32_16x16x32_bf16 v[188:191], v[132:135], a[4:7], v[188:191]
v_exp_f32 v179, v179
v_mfma_f32_16x16x32_bf16 v[184:187], v[120:123], a[8:11], v[184:187]
v_exp_f32 v180, v180
v_mfma_f32_16x16x32_bf16 v[188:191], v[136:139], a[8:11], v[188:191]
v_exp_f32 v181, v181
v_mfma_f32_16x16x32_bf16 v[184:187], v[124:127], a[12:15], v[184:187]
v_exp_f32 v182, v182
v_mfma_f32_16x16x32_bf16 v[188:191], v[140:143], a[12:15], v[188:191]
v_exp_f32 v183, v183
v_mfma_f32_16x16x32_bf16 a[244:247], v[228:231], v[196:199], a[244:247]
v_cvt_pk_bf16_f32 v192, v176, v177
v_cvt_pk_bf16_f32 v193, v178, v179
v_mfma_f32_16x16x32_bf16 v[20:23], v[144:147], v[196:199], v[20:23]
v_cvt_pk_bf16_f32 v194, v180, v181
v_cvt_pk_bf16_f32 v195, v182, v183
v_mfma_f32_16x16x32_bf16 v[48:51], v[148:151], v[196:199], v[48:51]
v_mfma_f32_16x16x32_bf16 v[76:79], v[152:155], v[196:199], v[76:79]
v_mfma_f32_16x16x32_bf16 v[104:107], v[156:159], v[196:199], v[104:107]
v_mfma_f32_16x16x32_bf16 a[132:135], v[160:163], v[196:199], a[132:135]
v_mfma_f32_16x16x32_bf16 a[160:163], v[164:167], v[196:199], a[160:163]
v_mfma_f32_16x16x32_bf16 a[188:191], v[168:171], v[196:199], a[188:191]
v_mfma_f32_16x16x32_bf16 a[216:219], v[172:175], v[196:199], a[216:219]
v_mfma_f32_16x16x32_bf16 v[176:179], v[112:115], a[16:19], v[204:207]
v_exp_f32 v184, v184
v_mfma_f32_16x16x32_bf16 v[180:183], v[128:131], a[16:19], v[204:207]
v_exp_f32 v185, v185
v_mfma_f32_16x16x32_bf16 v[176:179], v[116:119], a[20:23], v[176:179]
v_exp_f32 v186, v186
v_mfma_f32_16x16x32_bf16 v[180:183], v[132:135], a[20:23], v[180:183]
v_exp_f32 v187, v187
v_mfma_f32_16x16x32_bf16 v[176:179], v[120:123], a[24:27], v[176:179]
v_exp_f32 v188, v188
v_mfma_f32_16x16x32_bf16 v[180:183], v[136:139], a[24:27], v[180:183]
v_exp_f32 v189, v189
v_mfma_f32_16x16x32_bf16 v[176:179], v[124:127], a[28:31], v[176:179]
v_exp_f32 v190, v190
v_mfma_f32_16x16x32_bf16 v[180:183], v[140:143], a[28:31], v[180:183]
v_exp_f32 v191, v191
v_mfma_f32_16x16x32_bf16 a[248:251], v[228:231], v[192:195], a[248:251]
v_cvt_pk_bf16_f32 v196, v184, v185
v_cvt_pk_bf16_f32 v197, v186, v187
v_cvt_pk_bf16_f32 v198, v188, v189
v_cvt_pk_bf16_f32 v199, v190, v191
s_waitcnt vmcnt(13)
v_mfma_f32_16x16x32_bf16 v[24:27], v[144:147], v[192:195], v[24:27]
ds_read_b64_tr_b16 v[144:145], v236 offset:16384
ds_read_b64_tr_b16 v[146:147], v236 offset:20480
v_mfma_f32_16x16x32_bf16 v[52:55], v[148:151], v[192:195], v[52:55]
ds_read_b64_tr_b16 v[148:149], v237 offset:16384
ds_read_b64_tr_b16 v[150:151], v237 offset:20480
v_mfma_f32_16x16x32_bf16 v[80:83], v[152:155], v[192:195], v[80:83]
ds_read_b64_tr_b16 v[152:153], v238 offset:16384
ds_read_b64_tr_b16 v[154:155], v238 offset:20480
v_mfma_f32_16x16x32_bf16 v[108:111], v[156:159], v[192:195], v[108:111]
ds_read_b64_tr_b16 v[156:157], v239 offset:16384
ds_read_b64_tr_b16 v[158:159], v239 offset:20480
v_mfma_f32_16x16x32_bf16 a[136:139], v[160:163], v[192:195], a[136:139]
ds_read_b64_tr_b16 v[160:161], v240 offset:16384
ds_read_b64_tr_b16 v[162:163], v240 offset:20480
v_mfma_f32_16x16x32_bf16 a[164:167], v[164:167], v[192:195], a[164:167]
ds_read_b64_tr_b16 v[164:165], v241 offset:16384
ds_read_b64_tr_b16 v[166:167], v241 offset:20480
v_mfma_f32_16x16x32_bf16 a[192:195], v[168:171], v[192:195], a[192:195]
ds_read_b64_tr_b16 v[168:169], v242 offset:16384
ds_read_b64_tr_b16 v[170:171], v242 offset:20480
v_mfma_f32_16x16x32_bf16 a[220:223], v[172:175], v[192:195], a[220:223]
ds_read_b64_tr_b16 v[172:173], v243 offset:16384
ds_read_b64_tr_b16 v[174:175], v243 offset:20480
v_mfma_f32_16x16x32_bf16 v[184:187], v[112:115], a[32:35], v[208:211]
v_exp_f32 v176, v176
v_mfma_f32_16x16x32_bf16 v[188:191], v[128:131], a[32:35], v[208:211]
v_exp_f32 v177, v177
v_mfma_f32_16x16x32_bf16 v[184:187], v[116:119], a[36:39], v[184:187]
v_exp_f32 v178, v178
v_mfma_f32_16x16x32_bf16 v[188:191], v[132:135], a[36:39], v[188:191]
v_exp_f32 v179, v179
v_mfma_f32_16x16x32_bf16 v[184:187], v[120:123], a[40:43], v[184:187]
v_exp_f32 v180, v180
v_mfma_f32_16x16x32_bf16 v[188:191], v[136:139], a[40:43], v[188:191]
v_exp_f32 v181, v181
v_mfma_f32_16x16x32_bf16 v[184:187], v[124:127], a[44:47], v[184:187]
v_exp_f32 v182, v182
v_mfma_f32_16x16x32_bf16 v[188:191], v[140:143], a[44:47], v[188:191]
v_exp_f32 v183, v183
s_waitcnt vmcnt(9) lgkmcnt(0)
v_mfma_f32_16x16x32_bf16 a[224:227], v[228:231], v[196:199], a[224:227]
v_cvt_pk_bf16_f32 v192, v176, v177
v_cvt_pk_bf16_f32 v193, v178, v179
v_mfma_f32_16x16x32_bf16 v[0:3], v[144:147], v[196:199], v[0:3]
v_cvt_pk_bf16_f32 v194, v180, v181
v_cvt_pk_bf16_f32 v195, v182, v183
v_mfma_f32_16x16x32_bf16 v[28:31], v[148:151], v[196:199], v[28:31]
v_mfma_f32_16x16x32_bf16 v[56:59], v[152:155], v[196:199], v[56:59]
v_mfma_f32_16x16x32_bf16 v[84:87], v[156:159], v[196:199], v[84:87]
v_mfma_f32_16x16x32_bf16 a[112:115], v[160:163], v[196:199], a[112:115]
v_mfma_f32_16x16x32_bf16 a[140:143], v[164:167], v[196:199], a[140:143]
v_mfma_f32_16x16x32_bf16 a[168:171], v[168:171], v[196:199], a[168:171]
v_mfma_f32_16x16x32_bf16 a[196:199], v[172:175], v[196:199], a[196:199]
v_mfma_f32_16x16x32_bf16 v[176:179], v[112:115], a[48:51], v[212:215]
v_exp_f32 v184, v184
v_mfma_f32_16x16x32_bf16 v[180:183], v[128:131], a[48:51], v[212:215]
v_exp_f32 v185, v185
v_mfma_f32_16x16x32_bf16 v[176:179], v[116:119], a[52:55], v[176:179]
v_exp_f32 v186, v186
v_mfma_f32_16x16x32_bf16 v[180:183], v[132:135], a[52:55], v[180:183]
v_exp_f32 v187, v187
v_mfma_f32_16x16x32_bf16 v[176:179], v[120:123], a[56:59], v[176:179]
v_exp_f32 v188, v188
v_mfma_f32_16x16x32_bf16 v[180:183], v[136:139], a[56:59], v[180:183]
v_exp_f32 v189, v189
v_mfma_f32_16x16x32_bf16 v[176:179], v[124:127], a[60:63], v[176:179]
v_exp_f32 v190, v190
v_mfma_f32_16x16x32_bf16 v[180:183], v[140:143], a[60:63], v[180:183]
v_exp_f32 v191, v191
v_mfma_f32_16x16x32_bf16 a[228:231], v[228:231], v[192:195], a[228:231]
v_cvt_pk_bf16_f32 v196, v184, v185
v_cvt_pk_bf16_f32 v197, v186, v187
v_mfma_f32_16x16x32_bf16 v[4:7], v[144:147], v[192:195], v[4:7]
v_cvt_pk_bf16_f32 v198, v188, v189
v_cvt_pk_bf16_f32 v199, v190, v191
v_mfma_f32_16x16x32_bf16 v[32:35], v[148:151], v[192:195], v[32:35]
ds_write_b128 v252, a[112:115] offset:2048
v_mfma_f32_16x16x32_bf16 v[60:63], v[152:155], v[192:195], v[60:63]
v_mfma_f32_16x16x32_bf16 v[88:91], v[156:159], v[192:195], v[88:91]
ds_write_b128 v252, a[140:143] offset:9216
v_mfma_f32_16x16x32_bf16 a[116:119], v[160:163], v[192:195], a[116:119]
v_mfma_f32_16x16x32_bf16 a[144:147], v[164:167], v[192:195], a[144:147]
ds_write_b128 v252, a[168:171] offset:16384
v_mfma_f32_16x16x32_bf16 a[172:175], v[168:171], v[192:195], a[172:175]
v_mfma_f32_16x16x32_bf16 a[200:203], v[172:175], v[192:195], a[200:203]
ds_write_b128 v252, a[196:199] offset:23552
v_mfma_f32_16x16x32_bf16 v[184:187], v[112:115], a[64:67], v[216:219]
v_exp_f32 v176, v176
v_mfma_f32_16x16x32_bf16 v[188:191], v[128:131], a[64:67], v[216:219]
v_exp_f32 v177, v177
v_mfma_f32_16x16x32_bf16 v[184:187], v[116:119], a[68:71], v[184:187]
v_exp_f32 v178, v178
v_mfma_f32_16x16x32_bf16 v[188:191], v[132:135], a[68:71], v[188:191]
v_exp_f32 v179, v179
v_mfma_f32_16x16x32_bf16 v[184:187], v[120:123], a[72:75], v[184:187]
v_exp_f32 v180, v180
v_mfma_f32_16x16x32_bf16 v[188:191], v[136:139], a[72:75], v[188:191]
v_exp_f32 v181, v181
v_mfma_f32_16x16x32_bf16 v[184:187], v[124:127], a[76:79], v[184:187]
v_exp_f32 v182, v182
v_mfma_f32_16x16x32_bf16 v[188:191], v[140:143], a[76:79], v[188:191]
v_exp_f32 v183, v183
v_mfma_f32_16x16x32_bf16 a[232:235], v[228:231], v[196:199], a[232:235]
v_cvt_pk_bf16_f32 v192, v176, v177
v_cvt_pk_bf16_f32 v193, v178, v179
v_mfma_f32_16x16x32_bf16 v[8:11], v[144:147], v[196:199], v[8:11]
v_cvt_pk_bf16_f32 v194, v180, v181
v_cvt_pk_bf16_f32 v195, v182, v183
v_mfma_f32_16x16x32_bf16 v[36:39], v[148:151], v[196:199], v[36:39]
ds_write_b128 v252, a[116:119] offset:3072
v_mfma_f32_16x16x32_bf16 v[64:67], v[152:155], v[196:199], v[64:67]
v_mfma_f32_16x16x32_bf16 v[92:95], v[156:159], v[196:199], v[92:95]
ds_write_b128 v252, a[144:147] offset:10240
v_mfma_f32_16x16x32_bf16 a[120:123], v[160:163], v[196:199], a[120:123]
v_mfma_f32_16x16x32_bf16 a[148:151], v[164:167], v[196:199], a[148:151]
ds_write_b128 v252, a[172:175] offset:17408
v_mfma_f32_16x16x32_bf16 a[176:179], v[168:171], v[196:199], a[176:179]
v_mfma_f32_16x16x32_bf16 a[204:207], v[172:175], v[196:199], a[204:207]
ds_write_b128 v252, a[200:203] offset:24576
v_mfma_f32_16x16x32_bf16 v[176:179], v[112:115], a[80:83], v[220:223]
v_exp_f32 v184, v184
v_mfma_f32_16x16x32_bf16 v[180:183], v[128:131], a[80:83], v[220:223]
v_exp_f32 v185, v185
v_mfma_f32_16x16x32_bf16 v[176:179], v[116:119], a[84:87], v[176:179]
v_exp_f32 v186, v186
v_mfma_f32_16x16x32_bf16 v[180:183], v[132:135], a[84:87], v[180:183]
v_exp_f32 v187, v187
v_mfma_f32_16x16x32_bf16 v[176:179], v[120:123], a[88:91], v[176:179]
v_exp_f32 v188, v188
v_mfma_f32_16x16x32_bf16 v[180:183], v[136:139], a[88:91], v[180:183]
v_exp_f32 v189, v189
v_mfma_f32_16x16x32_bf16 v[176:179], v[124:127], a[92:95], v[176:179]
v_exp_f32 v190, v190
v_mfma_f32_16x16x32_bf16 v[180:183], v[140:143], a[92:95], v[180:183]
v_exp_f32 v191, v191
v_mfma_f32_16x16x32_bf16 a[236:239], v[228:231], v[192:195], a[236:239]
v_cvt_pk_bf16_f32 v196, v184, v185
v_cvt_pk_bf16_f32 v197, v186, v187
v_mfma_f32_16x16x32_bf16 v[12:15], v[144:147], v[192:195], v[12:15]
v_cvt_pk_bf16_f32 v198, v188, v189
v_cvt_pk_bf16_f32 v199, v190, v191
v_mfma_f32_16x16x32_bf16 v[40:43], v[148:151], v[192:195], v[40:43]
ds_write_b128 v252, a[120:123] offset:4096
v_mfma_f32_16x16x32_bf16 v[68:71], v[152:155], v[192:195], v[68:71]
v_mfma_f32_16x16x32_bf16 v[96:99], v[156:159], v[192:195], v[96:99]
ds_write_b128 v252, a[148:151] offset:11264
v_mfma_f32_16x16x32_bf16 a[124:127], v[160:163], v[192:195], a[124:127]
v_mfma_f32_16x16x32_bf16 a[152:155], v[164:167], v[192:195], a[152:155]
ds_write_b128 v252, a[176:179] offset:18432
v_mfma_f32_16x16x32_bf16 a[180:183], v[168:171], v[192:195], a[180:183]
v_mfma_f32_16x16x32_bf16 a[208:211], v[172:175], v[192:195], a[208:211]
ds_write_b128 v252, a[204:207] offset:25600
v_mfma_f32_16x16x32_bf16 v[184:187], v[112:115], a[96:99], v[224:227]
v_exp_f32 v176, v176
v_mfma_f32_16x16x32_bf16 v[188:191], v[128:131], a[96:99], v[224:227]
v_exp_f32 v177, v177
v_mfma_f32_16x16x32_bf16 v[184:187], v[116:119], a[100:103], v[184:187]
v_exp_f32 v178, v178
v_mfma_f32_16x16x32_bf16 v[188:191], v[132:135], a[100:103], v[188:191]
v_exp_f32 v179, v179
v_mfma_f32_16x16x32_bf16 v[184:187], v[120:123], a[104:107], v[184:187]
v_exp_f32 v180, v180
v_mfma_f32_16x16x32_bf16 v[188:191], v[136:139], a[104:107], v[188:191]
v_exp_f32 v181, v181
v_mfma_f32_16x16x32_bf16 v[184:187], v[124:127], a[108:111], v[184:187]
v_exp_f32 v182, v182
v_mfma_f32_16x16x32_bf16 v[188:191], v[140:143], a[108:111], v[188:191]
v_exp_f32 v183, v183
v_mfma_f32_16x16x32_bf16 a[240:243], v[228:231], v[196:199], a[240:243]
v_cvt_pk_bf16_f32 v192, v176, v177
v_cvt_pk_bf16_f32 v193, v178, v179
v_mfma_f32_16x16x32_bf16 v[16:19], v[144:147], v[196:199], v[16:19]
v_cvt_pk_bf16_f32 v194, v180, v181
v_cvt_pk_bf16_f32 v195, v182, v183
v_mfma_f32_16x16x32_bf16 v[44:47], v[148:151], v[196:199], v[44:47]
ds_write_b128 v252, a[124:127] offset:5120
v_mfma_f32_16x16x32_bf16 v[72:75], v[152:155], v[196:199], v[72:75]
v_mfma_f32_16x16x32_bf16 v[100:103], v[156:159], v[196:199], v[100:103]
ds_write_b128 v252, a[152:155] offset:12288
v_mfma_f32_16x16x32_bf16 a[128:131], v[160:163], v[196:199], a[128:131]
v_mfma_f32_16x16x32_bf16 a[156:159], v[164:167], v[196:199], a[156:159]
ds_write_b128 v252, a[180:183] offset:19456
v_mfma_f32_16x16x32_bf16 a[184:187], v[168:171], v[196:199], a[184:187]
v_mfma_f32_16x16x32_bf16 a[212:215], v[172:175], v[196:199], a[212:215]
ds_write_b128 v252, a[208:211] offset:26624
v_mfma_f32_16x16x32_bf16 a[244:247], v[228:231], v[192:195], a[244:247]
v_exp_f32 v184, v184
v_mfma_f32_16x16x32_bf16 v[20:23], v[144:147], v[192:195], v[20:23]
v_exp_f32 v185, v185
v_mfma_f32_16x16x32_bf16 v[48:51], v[148:151], v[192:195], v[48:51]
v_exp_f32 v186, v186
v_mfma_f32_16x16x32_bf16 v[76:79], v[152:155], v[192:195], v[76:79]
v_exp_f32 v187, v187
v_mfma_f32_16x16x32_bf16 v[104:107], v[156:159], v[192:195], v[104:107]
v_exp_f32 v188, v188
ds_write_b128 v252, a[128:131] offset:6144
v_mfma_f32_16x16x32_bf16 a[132:135], v[160:163], v[192:195], a[132:135]
v_exp_f32 v189, v189
ds_write_b128 v252, a[156:159] offset:13312
v_mfma_f32_16x16x32_bf16 a[160:163], v[164:167], v[192:195], a[160:163]
v_exp_f32 v190, v190
ds_write_b128 v252, a[184:187] offset:20480
v_mfma_f32_16x16x32_bf16 a[188:191], v[168:171], v[192:195], a[188:191]
v_exp_f32 v191, v191
ds_write_b128 v252, a[212:215] offset:27648
v_mfma_f32_16x16x32_bf16 a[216:219], v[172:175], v[192:195], a[216:219]
v_cvt_pk_bf16_f32 v196, v184, v185
v_cvt_pk_bf16_f32 v197, v186, v187
v_cvt_pk_bf16_f32 v198, v188, v189
v_cvt_pk_bf16_f32 v199, v190, v191
s_nop 1
v_mfma_f32_16x16x32_bf16 a[248:251], v[228:231], v[196:199], a[248:251]
v_accvgpr_read_b32 v112, a224
v_accvgpr_read_b32 v113, a228
v_mfma_f32_16x16x32_bf16 a[136:139], v[160:163], v[196:199], a[136:139]
v_accvgpr_read_b32 v114, a232
v_accvgpr_read_b32 v115, a236
v_mfma_f32_16x16x32_bf16 a[164:167], v[164:167], v[196:199], a[164:167]
ds_write_b128 v252, a[132:135] offset:7168
v_accvgpr_read_b32 v116, a240
v_mfma_f32_16x16x32_bf16 a[192:195], v[168:171], v[196:199], a[192:195]
ds_write_b128 v252, a[160:163] offset:14336
v_accvgpr_read_b32 v117, a244
v_mfma_f32_16x16x32_bf16 a[220:223], v[172:175], v[196:199], a[220:223]
ds_write_b128 v252, a[188:191] offset:21504
v_accvgpr_read_b32 v118, a248
v_mfma_f32_16x16x32_bf16 v[24:27], v[144:147], v[196:199], v[24:27]
ds_write_b128 v252, a[216:219] offset:28672
v_min3_f32 v120, v112, v113, v114
v_max3_f32 v121, v112, v113, v114
v_mfma_f32_16x16x32_bf16 v[52:55], v[148:151], v[196:199], v[52:55]
ds_write_b128 v252, a[136:139] offset:8192
v_min3_f32 v120, v115, v116, v120
v_max3_f32 v121, v115, v116, v121
v_mfma_f32_16x16x32_bf16 v[80:83], v[152:155], v[196:199], v[80:83]
ds_write_b128 v252, a[164:167] offset:15360
v_min3_f32 v120, v117, v118, v120
v_max3_f32 v121, v117, v118, v121
v_mfma_f32_16x16x32_bf16 v[108:111], v[156:159], v[196:199], v[108:111]
ds_write_b128 v252, a[192:195] offset:22528
v_cmp_nle_f32 vcc, 0x33800000, v120
ds_write_b128 v252, v[112:115] offset:0
ds_write_b128 v252, a[220:223] offset:29696
v_cndmask_b32 v119, 0, v228, vcc
v_cmp_nge_f32 vcc, 0x4b000000, v121
s_waitcnt vmcnt(0)
v_xor_b32 v253, 65536, v252
v_xor_b32 v254, 65536, v251
v_cndmask_b32 v119, v119, v228, vcc
ds_write_b128 v252, v[116:119] offset:1024
s_waitcnt lgkmcnt(0)
s_barrier
ds_read_b128 v[120:123], v251 offset:0
ds_read_b128 v[124:127], v251 offset:1024
ds_read_b32 v128, v253 offset:1036
ds_read_b32 v129, v254 offset:1036
ds_read_b128 v[168:171], v251 offset:16384
ds_read_b128 v[196:199], v251 offset:23552
ds_read_b128 v[172:175], v251 offset:17408
ds_read_b128 v[200:203], v251 offset:24576
ds_read_b128 v[176:179], v251 offset:18432
ds_read_b128 v[204:207], v251 offset:25600
ds_read_b128 v[180:183], v251 offset:19456
ds_read_b128 v[208:211], v251 offset:26624
ds_read_b128 v[184:187], v251 offset:20480
ds_read_b128 v[212:215], v251 offset:27648
ds_read_b128 v[188:191], v251 offset:21504
ds_read_b128 v[216:219], v251 offset:28672
ds_read_b128 v[192:195], v251 offset:22528
ds_read_b128 v[220:223], v251 offset:29696
s_waitcnt lgkmcnt(14)
v_or3_b32 v119, v119, v127, v128
v_or_b32 v119, v119, v129
v_cmp_ne_u32 vcc, 0, v119
v_add_f32 v112, v112, v120
v_add_f32 v113, v113, v121
v_add_f32 v114, v114, v122
v_add_f32 v115, v115, v123
v_add_f32 v116, v116, v124
v_add_f32 v117, v117, v125
v_add_f32 v118, v118, v126
s_cbranch_vccz L1_fin
s_cmp_eq_u32 s57, 0
s_cbranch_scc1 L1_slow
L1_fin:
v_rcp_f32 v228, v112
v_rcp_f32 v230, v113
v_rcp_f32 v232, v114
v_rcp_f32 v234, v115
v_rcp_f32 v236, v116
v_rcp_f32 v238, v117
v_rcp_f32 v240, v118
ds_read_b128 v[112:115], v251 offset:2048
ds_read_b128 v[140:143], v251 offset:9216
ds_read_b128 v[116:119], v251 offset:3072
ds_read_b128 v[144:147], v251 offset:10240
ds_read_b128 v[120:123], v251 offset:4096
ds_read_b128 v[148:151], v251 offset:11264
ds_read_b128 v[124:127], v251 offset:5120
ds_read_b128 v[152:155], v251 offset:12288
ds_read_b128 v[128:131], v251 offset:6144
ds_read_b128 v[156:159], v251 offset:13312
ds_read_b128 v[132:135], v251 offset:7168
ds_read_b128 v[160:163], v251 offset:14336
ds_read_b128 v[136:139], v251 offset:8192
ds_read_b128 v[164:167], v251 offset:15360
v_accvgpr_read_b32 v242, a252
v_accvgpr_read_b32 v246, a253
v_add_u32 v225, 8192, v255
v_xor_b32 v243, 32768, v242
v_xor_b32 v247, 8192, v246
v_add_u32 v226, 16384, v255
v_xor_b32 v244, 65536, v242
v_xor_b32 v248, 16384, v246
v_add_u32 v227, 24576, v255
v_xor_b32 v245, 98304, v242
v_xor_b32 v249, 24576, v246
s_waitcnt lgkmcnt(14)
s_add_u32 m0, s100, 16384
s_add_u32 s96, s96, 128
s_cmp_eq_u32 s96, s98
s_cselect_b32 s96, s97, s96
buffer_load_dwordx4 v255, s[92:95], s96 offen offset:0  lds
v_pk_add_f32 v[56:57], v[56:57], v[168:169]
v_pk_add_f32 v[58:59], v[58:59], v[170:171]
v_pk_add_f32 v[84:85], v[84:85], v[196:197]
v_pk_add_f32 v[86:87], v[86:87], v[198:199]
buffer_load_dwordx4 v225, s[92:95], s96 offen offset:1024  lds
v_pk_mul_f32 v[56:57], v[56:57], v[228:229] op_sel_hi:[1,0]
v_pk_mul_f32 v[58:59], v[58:59], v[228:229] op_sel_hi:[1,0]
v_pk_mul_f32 v[84:85], v[84:85], v[228:229] op_sel_hi:[1,0]
v_pk_mul_f32 v[86:87], v[86:87], v[228:229] op_sel_hi:[1,0]
v_cvt_pk_bf16_f32 v168, v56, v57
v_cvt_pk_bf16_f32 v169, v58, v59
v_cvt_pk_bf16_f32 v170, v84, v85
v_cvt_pk_bf16_f32 v171, v86, v87
s_waitcnt lgkmcnt(0)
ds_write_b128 v251, v[168:171] offset:9216
buffer_load_dwordx4 v226, s[92:95], s96 offen offset:2048  lds
v_pk_add_f32 v[60:61], v[60:61], v[172:173]
v_pk_add_f32 v[62:63], v[62:63], v[174:175]
v_pk_add_f32 v[88:89], v[88:89], v[200:201]
v_pk_add_f32 v[90:91], v[90:91], v[202:203]
v_pk_mul_f32 v[60:61], v[60:61], v[230:231] op_sel_hi:[1,0]
v_pk_mul_f32 v[62:63], v[62:63], v[230:231] op_sel_hi:[1,0]
v_pk_mul_f32 v[88:89], v[88:89], v[230:231] op_sel_hi:[1,0]
v_pk_mul_f32 v[90:91], v[90:91], v[230:231] op_sel_hi:[1,0]
v_cvt_pk_bf16_f32 v172, v60, v61
v_cvt_pk_bf16_f32 v173, v62, v63
v_cvt_pk_bf16_f32 v174, v88, v89
v_cvt_pk_bf16_f32 v175, v90, v91
ds_write_b128 v251, v[172:175] offset:10240
buffer_load_dwordx4 v227, s[92:95], s96 offen offset:3072  lds
v_pk_add_f32 v[64:65], v[64:65], v[176:177]
v_pk_add_f32 v[66:67], v[66:67], v[178:179]
v_pk_add_f32 v[92:93], v[92:93], v[204:205]
v_pk_add_f32 v[94:95], v[94:95], v[206:207]
v_pk_mul_f32 v[64:65], v[64:65], v[232:233] op_sel_hi:[1,0]
v_pk_mul_f32 v[66:67], v[66:67], v[232:233] op_sel_hi:[1,0]
v_pk_mul_f32 v[92:93], v[92:93], v[232:233] op_sel_hi:[1,0]
v_pk_mul_f32 v[94:95], v[94:95], v[232:233] op_sel_hi:[1,0]
v_cvt_pk_bf16_f32 v176, v64, v65
v_cvt_pk_bf16_f32 v177, v66, v67
v_cvt_pk_bf16_f32 v178, v92, v93
v_cvt_pk_bf16_f32 v179, v94, v95
ds_write_b128 v251, v[176:179] offset:11264
s_add_u32 m0, s100, 20480
s_add_u32 s51, s96, 36864
buffer_load_dwordx4 v255, s[92:95], s51 offen offset:0  lds
v_pk_add_f32 v[68:69], v[68:69], v[180:181]
v_pk_add_f32 v[70:71], v[70:71], v[182:183]
v_pk_add_f32 v[96:97], v[96:97], v[208:209]
v_pk_add_f32 v[98:99], v[98:99], v[210:211]
v_pk_mul_f32 v[68:69], v[68:69], v[234:235] op_sel_hi:[1,0]
v_pk_mul_f32 v[70:71], v[70:71], v[234:235] op_sel_hi:[1,0]
v_pk_mul_f32 v[96:97], v[96:97], v[234:235] op_sel_hi:[1,0]
v_pk_mul_f32 v[98:99], v[98:99], v[234:235] op_sel_hi:[1,0]
v_cvt_pk_bf16_f32 v180, v68, v69
v_cvt_pk_bf16_f32 v181, v70, v71
v_cvt_pk_bf16_f32 v182, v96, v97
v_cvt_pk_bf16_f32 v183, v98, v99
ds_write_b128 v251, v[180:183] offset:12288
buffer_load_dwordx4 v225, s[92:95], s51 offen offset:1024  lds
v_pk_add_f32 v[72:73], v[72:73], v[184:185]
v_pk_add_f32 v[74:75], v[74:75], v[186:187]
v_pk_add_f32 v[100:101], v[100:101], v[212:213]
v_pk_add_f32 v[102:103], v[102:103], v[214:215]
v_pk_mul_f32 v[72:73], v[72:73], v[236:237] op_sel_hi:[1,0]
v_pk_mul_f32 v[74:75], v[74:75], v[236:237] op_sel_hi:[1,0]
v_pk_mul_f32 v[100:101], v[100:101], v[236:237] op_sel_hi:[1,0]
v_pk_mul_f32 v[102:103], v[102:103], v[236:237] op_sel_hi:[1,0]
v_cvt_pk_bf16_f32 v184, v72, v73
v_cvt_pk_bf16_f32 v185, v74, v75
v_cvt_pk_bf16_f32 v186, v100, v101
v_cvt_pk_bf16_f32 v187, v102, v103
ds_write_b128 v251, v[184:187] offset:13312
buffer_load_dwordx4 v226, s[92:95], s51 offen offset:2048  lds
v_pk_add_f32 v[76:77], v[76:77], v[188:189]
v_pk_add_f32 v[78:79], v[78:79], v[190:191]
v_pk_add_f32 v[104:105], v[104:105], v[216:217]
v_pk_add_f32 v[106:107], v[106:107], v[218:219]
v_pk_mul_f32 v[76:77], v[76:77], v[238:239] op_sel_hi:[1,0]
v_pk_mul_f32 v[78:79], v[78:79], v[238:239] op_sel_hi:[1,0]
v_pk_mul_f32 v[104:105], v[104:105], v[238:239] op_sel_hi:[1,0]
v_pk_mul_f32 v[106:107], v[106:107], v[238:239] op_sel_hi:[1,0]
v_cvt_pk_bf16_f32 v188, v76, v77
v_cvt_pk_bf16_f32 v189, v78, v79
v_cvt_pk_bf16_f32 v190, v104, v105
v_cvt_pk_bf16_f32 v191, v106, v107
ds_write_b128 v251, v[188:191] offset:14336
buffer_load_dwordx4 v227, s[92:95], s51 offen offset:3072  lds
v_pk_add_f32 v[80:81], v[80:81], v[192:193]
v_pk_add_f32 v[82:83], v[82:83], v[194:195]
v_pk_add_f32 v[108:109], v[108:109], v[220:221]
v_pk_add_f32 v[110:111], v[110:111], v[222:223]
v_pk_mul_f32 v[80:81], v[80:81], v[240:241] op_sel_hi:[1,0]
v_pk_mul_f32 v[82:83], v[82:83], v[240:241] op_sel_hi:[1,0]
v_pk_mul_f32 v[108:109], v[108:109], v[240:241] op_sel_hi:[1,0]
v_pk_mul_f32 v[110:111], v[110:111], v[240:241] op_sel_hi:[1,0]
v_cvt_pk_bf16_f32 v192, v80, v81
v_cvt_pk_bf16_f32 v193, v82, v83
v_cvt_pk_bf16_f32 v194, v108, v109
v_cvt_pk_bf16_f32 v195, v110, v111
ds_write_b128 v251, v[192:195] offset:15360
s_add_u32 m0, s100, 24576
s_add_u32 s96, s96, 128
s_cmp_eq_u32 s96, s98
s_cselect_b32 s96, s97, s96
buffer_load_dwordx4 v255, s[92:95], s96 offen offset:0  lds
v_pk_add_f32 v[0:1], v[0:1], v[112:113]
v_pk_add_f32 v[2:3], v[2:3], v[114:115]
v_pk_add_f32 v[28:29], v[28:29], v[140:141]
v_pk_add_f32 v[30:31], v[30:31], v[142:143]
ds_read_b64_tr_b16 v[56:57], v246 offset:0
ds_read_b64_tr_b16 v[58:59], v246 offset:2048
v_pk_mul_f32 v[0:1], v[0:1], v[228:229] op_sel_hi:[1,0]
v_pk_mul_f32 v[2:3], v[2:3], v[228:229] op_sel_hi:[1,0]
v_pk_mul_f32 v[28:29], v[28:29], v[228:229] op_sel_hi:[1,0]
v_pk_mul_f32 v[30:31], v[30:31], v[228:229] op_sel_hi:[1,0]
ds_read_b64_tr_b16 v[60:61], v246 offset:4096
ds_read_b64_tr_b16 v[62:63], v246 offset:6144
v_cvt_pk_bf16_f32 v112, v0, v1
v_cvt_pk_bf16_f32 v113, v2, v3
v_cvt_pk_bf16_f32 v114, v28, v29
v_cvt_pk_bf16_f32 v115, v30, v31
ds_write_b128 v251, v[112:115] offset:2048
buffer_load_dwordx4 v225, s[92:95], s96 offen offset:1024  lds
v_pk_add_f32 v[4:5], v[4:5], v[116:117]
v_pk_add_f32 v[6:7], v[6:7], v[118:119]
v_pk_add_f32 v[32:33], v[32:33], v[144:145]
v_pk_add_f32 v[34:35], v[34:35], v[146:147]
ds_read_b64_tr_b16 v[64:65], v247 offset:0
ds_read_b64_tr_b16 v[66:67], v247 offset:2048
v_pk_mul_f32 v[4:5], v[4:5], v[230:231] op_sel_hi:[1,0]
v_pk_mul_f32 v[6:7], v[6:7], v[230:231] op_sel_hi:[1,0]
v_pk_mul_f32 v[32:33], v[32:33], v[230:231] op_sel_hi:[1,0]
v_pk_mul_f32 v[34:35], v[34:35], v[230:231] op_sel_hi:[1,0]
ds_read_b64_tr_b16 v[68:69], v247 offset:4096
ds_read_b64_tr_b16 v[70:71], v247 offset:6144
v_cvt_pk_bf16_f32 v116, v4, v5
v_cvt_pk_bf16_f32 v117, v6, v7
v_cvt_pk_bf16_f32 v118, v32, v33
v_cvt_pk_bf16_f32 v119, v34, v35
ds_write_b128 v251, v[116:119] offset:3072
buffer_load_dwordx4 v226, s[92:95], s96 offen offset:2048  lds
v_pk_add_f32 v[8:9], v[8:9], v[120:121]
v_pk_add_f32 v[10:11], v[10:11], v[122:123]
v_pk_add_f32 v[36:37], v[36:37], v[148:149]
v_pk_add_f32 v[38:39], v[38:39], v[150:151]
ds_read_b64_tr_b16 v[72:73], v248 offset:0
ds_read_b64_tr_b16 v[74:75], v248 offset:2048
v_pk_mul_f32 v[8:9], v[8:9], v[232:233] op_sel_hi:[1,0]
v_pk_mul_f32 v[10:11], v[10:11], v[232:233] op_sel_hi:[1,0]
v_pk_mul_f32 v[36:37], v[36:37], v[232:233] op_sel_hi:[1,0]
v_pk_mul_f32 v[38:39], v[38:39], v[232:233] op_sel_hi:[1,0]
ds_read_b64_tr_b16 v[76:77], v248 offset:4096
ds_read_b64_tr_b16 v[78:79], v248 offset:6144
v_cvt_pk_bf16_f32 v120, v8, v9
v_cvt_pk_bf16_f32 v121, v10, v11
v_cvt_pk_bf16_f32 v122, v36, v37
v_cvt_pk_bf16_f32 v123, v38, v39
ds_write_b128 v251, v[120:123] offset:4096
buffer_load_dwordx4 v227, s[92:95], s96 offen offset:3072  lds
v_pk_add_f32 v[12:13], v[12:13], v[124:125]
v_pk_add_f32 v[14:15], v[14:15], v[126:127]
v_pk_add_f32 v[40:41], v[40:41], v[152:153]
v_pk_add_f32 v[42:43], v[42:43], v[154:155]
ds_read_b64_tr_b16 v[80:81], v249 offset:0
ds_read_b64_tr_b16 v[82:83], v249 offset:2048
v_pk_mul_f32 v[12:13], v[12:13], v[234:235] op_sel_hi:[1,0]
v_pk_mul_f32 v[14:15], v[14:15], v[234:235] op_sel_hi:[1,0]
v_pk_mul_f32 v[40:41], v[40:41], v[234:235] op_sel_hi:[1,0]
v_pk_mul_f32 v[42:43], v[42:43], v[234:235] op_sel_hi:[1,0]
ds_read_b64_tr_b16 v[84:85], v249 offset:4096
ds_read_b64_tr_b16 v[86:87], v249 offset:6144
v_cvt_pk_bf16_f32 v124, v12, v13
v_cvt_pk_bf16_f32 v125, v14, v15
v_cvt_pk_bf16_f32 v126, v40, v41
v_cvt_pk_bf16_f32 v127, v42, v43
ds_write_b128 v251, v[124:127] offset:5120
s_add_u32 m0, s100, 28672
s_add_u32 s51, s96, 36864
buffer_load_dwordx4 v255, s[92:95], s51 offen offset:0  lds
v_pk_add_f32 v[16:17], v[16:17], v[128:129]
v_pk_add_f32 v[18:19], v[18:19], v[130:131]
v_pk_add_f32 v[44:45], v[44:45], v[156:157]
v_pk_add_f32 v[46:47], v[46:47], v[158:159]
v_pk_mul_f32 v[16:17], v[16:17], v[236:237] op_sel_hi:[1,0]
v_pk_mul_f32 v[18:19], v[18:19], v[236:237] op_sel_hi:[1,0]
v_pk_mul_f32 v[44:45], v[44:45], v[236:237] op_sel_hi:[1,0]
v_pk_mul_f32 v[46:47], v[46:47], v[236:237] op_sel_hi:[1,0]
v_cvt_pk_bf16_f32 v128, v16, v17
v_cvt_pk_bf16_f32 v129, v18, v19
v_cvt_pk_bf16_f32 v130, v44, v45
v_cvt_pk_bf16_f32 v131, v46, v47
ds_write_b128 v251, v[128:131] offset:6144
buffer_load_dwordx4 v225, s[92:95], s51 offen offset:1024  lds
v_pk_add_f32 v[20:21], v[20:21], v[132:133]
v_pk_add_f32 v[22:23], v[22:23], v[134:135]
v_pk_add_f32 v[48:49], v[48:49], v[160:161]
v_pk_add_f32 v[50:51], v[50:51], v[162:163]
v_pk_mul_f32 v[20:21], v[20:21], v[238:239] op_sel_hi:[1,0]
v_pk_mul_f32 v[22:23], v[22:23], v[238:239] op_sel_hi:[1,0]
v_pk_mul_f32 v[48:49], v[48:49], v[238:239] op_sel_hi:[1,0]
v_pk_mul_f32 v[50:51], v[50:51], v[238:239] op_sel_hi:[1,0]
v_cvt_pk_bf16_f32 v132, v20, v21
v_cvt_pk_bf16_f32 v133, v22, v23
v_cvt_pk_bf16_f32 v134, v48, v49
v_cvt_pk_bf16_f32 v135, v50, v51
ds_write_b128 v251, v[132:135] offset:7168
buffer_load_dwordx4 v226, s[92:95], s51 offen offset:2048  lds
v_pk_add_f32 v[24:25], v[24:25], v[136:137]
v_pk_add_f32 v[26:27], v[26:27], v[138:139]
v_pk_add_f32 v[52:53], v[52:53], v[164:165]
v_pk_add_f32 v[54:55], v[54:55], v[166:167]
v_pk_mul_f32 v[24:25], v[24:25], v[240:241] op_sel_hi:[1,0]
v_pk_mul_f32 v[26:27], v[26:27], v[240:241] op_sel_hi:[1,0]
v_pk_mul_f32 v[52:53], v[52:53], v[240:241] op_sel_hi:[1,0]
v_pk_mul_f32 v[54:55], v[54:55], v[240:241] op_sel_hi:[1,0]
v_cvt_pk_bf16_f32 v136, v24, v25
v_cvt_pk_bf16_f32 v137, v26, v27
v_cvt_pk_bf16_f32 v138, v52, v53
v_cvt_pk_bf16_f32 v139, v54, v55
ds_write_b128 v251, v[136:139] offset:8192
s_waitcnt lgkmcnt(3)
v_mfma_f32_16x16x32_bf16 v[196:199], v[60:63], v[168:171], 0
buffer_load_dwordx4 v227, s[92:95], s51 offen offset:3072  lds
v_mfma_f32_16x16x32_bf16 v[200:203], v[60:63], v[172:175], 0
v_mfma_f32_16x16x32_bf16 v[204:207], v[60:63], v[176:179], 0
v_mfma_f32_16x16x32_bf16 v[208:211], v[60:63], v[180:183], 0
v_mfma_f32_16x16x32_bf16 v[212:215], v[60:63], v[184:187], 0
v_mfma_f32_16x16x32_bf16 v[216:219], v[60:63], v[188:191], 0
v_mfma_f32_16x16x32_bf16 v[220:223], v[60:63], v[192:195], 0
s_waitcnt lgkmcnt(0)
s_barrier
ds_read_b128 a[0:3], v252 offset:2048
ds_read_b128 a[4:7], v252 offset:3072
ds_read_b128 a[8:11], v252 offset:4096
ds_read_b128 a[12:15], v252 offset:5120
ds_read_b128 a[16:19], v252 offset:6144
ds_read_b128 a[20:23], v252 offset:7168
ds_read_b128 a[24:27], v252 offset:8192
s_add_u32 m0, s99, 0
s_add_u32 s96, s96, 128
v_mfma_f32_16x16x32_bf16 v[196:199], v[56:59], v[112:115], v[196:199]
ds_read_b128 a[28:31], v252 offset:9216
ds_read_b128 a[32:35], v252 offset:10240
s_cmp_eq_u32 s96, s98
s_cselect_b32 s96, s97, s96
v_mfma_f32_16x16x32_bf16 v[200:203], v[56:59], v[116:119], v[200:203]
ds_read_b128 a[36:39], v252 offset:11264
ds_read_b128 a[40:43], v252 offset:12288
v_mfma_f32_16x16x32_bf16 v[204:207], v[56:59], v[120:123], v[204:207]
buffer_load_dwordx4 v255, s[92:95], s96 offen offset:0  lds
ds_read_b128 a[44:47], v252 offset:13312
ds_read_b128 a[48:51], v252 offset:14336
v_mfma_f32_16x16x32_bf16 v[208:211], v[56:59], v[124:127], v[208:211]
ds_read_b128 a[52:55], v252 offset:15360
ds_read_b128 a[56:59], v254 offset:2048
v_mfma_f32_16x16x32_bf16 v[212:215], v[56:59], v[128:131], v[212:215]
ds_read_b128 a[60:63], v254 offset:3072
ds_read_b128 a[64:67], v254 offset:4096
v_mfma_f32_16x16x32_bf16 v[216:219], v[56:59], v[132:135], v[216:219]
buffer_load_dwordx4 v225, s[92:95], s96 offen offset:1024  lds
ds_read_b128 a[68:71], v254 offset:5120
ds_read_b128 a[72:75], v254 offset:6144
v_mfma_f32_16x16x32_bf16 v[220:223], v[56:59], v[136:139], v[220:223]
ds_read_b128 a[76:79], v254 offset:7168
ds_read_b128 a[80:83], v254 offset:8192
s_waitcnt lgkmcnt(14)
v_mfma_f32_16x16x32_bf16 v[196:199], v[64:67], a[0:3], v[196:199]
ds_read_b128 a[84:87], v254 offset:9216
v_mfma_f32_16x16x32_bf16 v[200:203], v[64:67], a[4:7], v[200:203]
buffer_load_dwordx4 v226, s[92:95], s96 offen offset:2048  lds
ds_read_b128 a[88:91], v254 offset:10240
v_mfma_f32_16x16x32_bf16 v[204:207], v[64:67], a[8:11], v[204:207]
ds_read_b128 a[92:95], v254 offset:11264
v_mfma_f32_16x16x32_bf16 v[208:211], v[64:67], a[12:15], v[208:211]
ds_read_b128 a[96:99], v254 offset:12288
v_mfma_f32_16x16x32_bf16 v[212:215], v[64:67], a[16:19], v[212:215]
buffer_load_dwordx4 v227, s[92:95], s96 offen offset:3072  lds
ds_read_b128 a[100:103], v254 offset:13312
v_mfma_f32_16x16x32_bf16 v[216:219], v[64:67], a[20:23], v[216:219]
s_add_u32 m0, s99, 4096
ds_read_b128 a[104:107], v254 offset:14336
v_mfma_f32_16x16x32_bf16 v[220:223], v[64:67], a[24:27], v[220:223]
s_add_u32 s51, s96, 36864
ds_read_b128 a[108:111], v254 offset:15360
s_waitcnt lgkmcnt(14)
v_mfma_f32_16x16x32_bf16 v[196:199], v[68:71], a[28:31], v[196:199]
buffer_load_dwordx4 v255, s[92:95], s51 offen offset:0  lds
ds_read_b128 a[112:115], v253 offset:2048
v_mfma_f32_16x16x32_bf16 v[200:203], v[68:71], a[32:35], v[200:203]
ds_read_b128 a[116:119], v253 offset:3072
v_mfma_f32_16x16x32_bf16 v[204:207], v[68:71], a[36:39], v[204:207]
ds_read_b128 a[120:123], v253 offset:4096
v_mfma_f32_16x16x32_bf16 v[208:211], v[68:71], a[40:43], v[208:211]
buffer_load_dwordx4 v225, s[92:95], s51 offen offset:1024  lds
ds_read_b128 a[124:127], v253 offset:5120
v_mfma_f32_16x16x32_bf16 v[212:215], v[68:71], a[44:47], v[212:215]
ds_read_b128 a[128:131], v253 offset:6144
v_mfma_f32_16x16x32_bf16 v[216:219], v[68:71], a[48:51], v[216:219]
ds_read_b128 a[132:135], v253 offset:7168
v_mfma_f32_16x16x32_bf16 v[220:223], v[68:71], a[52:55], v[220:223]
buffer_load_dwordx4 v226, s[92:95], s51 offen offset:2048  lds
ds_read_b128 a[136:139], v253 offset:8192
s_waitcnt lgkmcnt(14)
v_mfma_f32_16x16x32_bf16 v[196:199], v[72:75], a[56:59], v[196:199]
ds_read_b128 a[140:143], v253 offset:9216
v_mfma_f32_16x16x32_bf16 v[200:203], v[72:75], a[60:63], v[200:203]
ds_read_b128 a[144:147], v253 offset:10240
v_mfma_f32_16x16x32_bf16 v[204:207], v[72:75], a[64:67], v[204:207]
buffer_load_dwordx4 v227, s[92:95], s51 offen offset:3072  lds
ds_read_b128 a[148:151], v253 offset:11264
v_mfma_f32_16x16x32_bf16 v[208:211], v[72:75], a[68:71], v[208:211]
ds_read_b128 a[152:155], v253 offset:12288
v_mfma_f32_16x16x32_bf16 v[212:215], v[72:75], a[72:75], v[212:215]
ds_read_b128 a[156:159], v253 offset:13312
v_mfma_f32_16x16x32_bf16 v[216:219], v[72:75], a[76:79], v[216:219]
ds_read_b128 a[160:163], v253 offset:14336
v_mfma_f32_16x16x32_bf16 v[220:223], v[72:75], a[80:83], v[220:223]
ds_read_b128 a[164:167], v253 offset:15360
s_waitcnt lgkmcnt(14)
v_mfma_f32_16x16x32_bf16 v[196:199], v[76:79], a[84:87], v[196:199]
v_mfma_f32_16x16x32_bf16 v[200:203], v[76:79], a[88:91], v[200:203]
v_mfma_f32_16x16x32_bf16 v[204:207], v[76:79], a[92:95], v[204:207]
v_mfma_f32_16x16x32_bf16 v[208:211], v[76:79], a[96:99], v[208:211]
s_waitcnt vmcnt(16) lgkmcnt(0)
s_barrier
v_mfma_f32_16x16x32_bf16 v[212:215], v[76:79], a[100:103], v[212:215]
ds_read_b64_tr_b16 v[0:1], v242 offset:16384
v_mfma_f32_16x16x32_bf16 v[216:219], v[76:79], a[104:107], v[216:219]
ds_read_b64_tr_b16 v[2:3], v242 offset:18432
v_mfma_f32_16x16x32_bf16 v[220:223], v[76:79], a[108:111], v[220:223]
ds_read_b64_tr_b16 v[4:5], v242 offset:20480
v_mfma_f32_16x16x32_bf16 v[196:199], v[80:83], a[112:115], v[196:199]
ds_read_b64_tr_b16 v[6:7], v242 offset:22528
v_mfma_f32_16x16x32_bf16 v[200:203], v[80:83], a[116:119], v[200:203]
ds_read_b64_tr_b16 v[8:9], v243 offset:16384
v_mfma_f32_16x16x32_bf16 v[204:207], v[80:83], a[120:123], v[204:207]
ds_read_b64_tr_b16 v[10:11], v243 offset:18432
v_mfma_f32_16x16x32_bf16 v[208:211], v[80:83], a[124:127], v[208:211]
ds_read_b64_tr_b16 v[12:13], v243 offset:20480
v_mfma_f32_16x16x32_bf16 v[212:215], v[80:83], a[128:131], v[212:215]
ds_read_b64_tr_b16 v[14:15], v243 offset:22528
v_mfma_f32_16x16x32_bf16 v[216:219], v[80:83], a[132:135], v[216:219]
ds_read_b64_tr_b16 v[16:17], v244 offset:16384
v_mfma_f32_16x16x32_bf16 v[220:223], v[80:83], a[136:139], v[220:223]
ds_read_b64_tr_b16 v[18:19], v244 offset:18432
v_mfma_f32_16x16x32_bf16 v[196:199], v[84:87], a[140:143], v[196:199]
ds_read_b64_tr_b16 v[20:21], v244 offset:20480
v_mfma_f32_16x16x32_bf16 v[200:203], v[84:87], a[144:147], v[200:203]
ds_read_b64_tr_b16 v[22:23], v244 offset:22528
v_mfma_f32_16x16x32_bf16 v[204:207], v[84:87], a[148:151], v[204:207]
ds_read_b64_tr_b16 v[24:25], v245 offset:16384
v_mfma_f32_16x16x32_bf16 v[208:211], v[84:87], a[152:155], v[208:211]
ds_read_b64_tr_b16 v[26:27], v245 offset:18432
v_mfma_f32_16x16x32_bf16 v[212:215], v[84:87], a[156:159], v[212:215]
ds_read_b64_tr_b16 v[28:29], v245 offset:20480
v_mfma_f32_16x16x32_bf16 v[216:219], v[84:87], a[160:163], v[216:219]
ds_read_b64_tr_b16 v[30:31], v245 offset:22528
v_mfma_f32_16x16x32_bf16 v[220:223], v[84:87], a[164:167], v[220:223]
s_waitcnt lgkmcnt(0)
v_mfma_f32_16x16x32_bf16 v[140:143], v[4:7], v[168:171], 0
s_add_u32 m0, s100, 0
s_add_u32 s96, s96, 128
v_mfma_f32_16x16x32_bf16 v[144:147], v[4:7], v[172:175], 0
s_cmp_eq_u32 s96, s98
s_cselect_b32 s96, s97, s96
v_mfma_f32_16x16x32_bf16 v[148:151], v[4:7], v[176:179], 0
v_cvt_pk_bf16_f32 v32, v196, v197
v_mfma_f32_16x16x32_bf16 v[152:155], v[4:7], v[180:183], 0
buffer_load_dwordx4 v255, s[92:95], s96 offen offset:0  lds
v_mfma_f32_16x16x32_bf16 v[156:159], v[4:7], v[184:187], 0
v_cvt_pk_bf16_f32 v33, v198, v199
v_mfma_f32_16x16x32_bf16 v[160:163], v[4:7], v[188:191], 0
v_cvt_pk_bf16_f32 v34, v200, v201
v_mfma_f32_16x16x32_bf16 v[164:167], v[4:7], v[192:195], 0
buffer_load_dwordx4 v225, s[92:95], s96 offen offset:1024  lds
v_mfma_f32_16x16x32_bf16 v[140:143], v[0:3], v[112:115], v[140:143]
v_cvt_pk_bf16_f32 v35, v202, v203
v_mfma_f32_16x16x32_bf16 v[144:147], v[0:3], v[116:119], v[144:147]
v_cvt_pk_bf16_f32 v36, v204, v205
v_mfma_f32_16x16x32_bf16 v[148:151], v[0:3], v[120:123], v[148:151]
buffer_load_dwordx4 v226, s[92:95], s96 offen offset:2048  lds
v_mfma_f32_16x16x32_bf16 v[152:155], v[0:3], v[124:127], v[152:155]
v_cvt_pk_bf16_f32 v37, v206, v207
v_mfma_f32_16x16x32_bf16 v[156:159], v[0:3], v[128:131], v[156:159]
v_cvt_pk_bf16_f32 v38, v208, v209
v_mfma_f32_16x16x32_bf16 v[160:163], v[0:3], v[132:135], v[160:163]
buffer_load_dwordx4 v227, s[92:95], s96 offen offset:3072  lds
v_mfma_f32_16x16x32_bf16 v[164:167], v[0:3], v[136:139], v[164:167]
s_add_u32 m0, s100, 4096
v_mfma_f32_16x16x32_bf16 v[140:143], v[8:11], a[0:3], v[140:143]
s_add_u32 s51, s96, 36864
v_mfma_f32_16x16x32_bf16 v[144:147], v[8:11], a[4:7], v[144:147]
buffer_load_dwordx4 v255, s[92:95], s51 offen offset:0  lds
v_mfma_f32_16x16x32_bf16 v[148:151], v[8:11], a[8:11], v[148:151]
v_cvt_pk_bf16_f32 v39, v210, v211
v_mfma_f32_16x16x32_bf16 v[152:155], v[8:11], a[12:15], v[152:155]
v_cvt_pk_bf16_f32 v40, v212, v213
v_mfma_f32_16x16x32_bf16 v[156:159], v[8:11], a[16:19], v[156:159]
buffer_load_dwordx4 v225, s[92:95], s51 offen offset:1024  lds
v_mfma_f32_16x16x32_bf16 v[160:163], v[8:11], a[20:23], v[160:163]
v_cvt_pk_bf16_f32 v41, v214, v215
v_mfma_f32_16x16x32_bf16 v[164:167], v[8:11], a[24:27], v[164:167]
v_cvt_pk_bf16_f32 v42, v216, v217
v_mfma_f32_16x16x32_bf16 v[140:143], v[12:15], a[28:31], v[140:143]
buffer_load_dwordx4 v226, s[92:95], s51 offen offset:2048  lds
v_mfma_f32_16x16x32_bf16 v[144:147], v[12:15], a[32:35], v[144:147]
v_cvt_pk_bf16_f32 v43, v218, v219
v_mfma_f32_16x16x32_bf16 v[148:151], v[12:15], a[36:39], v[148:151]
v_cvt_pk_bf16_f32 v48, v220, v221
v_mfma_f32_16x16x32_bf16 v[152:155], v[12:15], a[40:43], v[152:155]
buffer_load_dwordx4 v227, s[92:95], s51 offen offset:3072  lds
v_mfma_f32_16x16x32_bf16 v[156:159], v[12:15], a[44:47], v[156:159]
v_cvt_pk_bf16_f32 v49, v222, v223
v_mfma_f32_16x16x32_bf16 v[160:163], v[12:15], a[48:51], v[160:163]
v_mfma_f32_16x16x32_bf16 v[164:167], v[12:15], a[52:55], v[164:167]
s_waitcnt vmcnt(16) lgkmcnt(0)
s_barrier
v_mfma_f32_16x16x32_bf16 v[140:143], v[16:19], a[56:59], v[140:143]
ds_read_b64_tr_b16 v[56:57], v242 offset:24576
v_mfma_f32_16x16x32_bf16 v[144:147], v[16:19], a[60:63], v[144:147]
ds_read_b64_tr_b16 v[58:59], v242 offset:26624
s_add_u32 s52, s39, 0
v_mfma_f32_16x16x32_bf16 v[148:151], v[16:19], a[64:67], v[148:151]
buffer_store_dwordx4 v[32:35], v250, s[20:23], s52 offen offset:0 sc1
v_mfma_f32_16x16x32_bf16 v[152:155], v[16:19], a[68:71], v[152:155]
ds_read_b64_tr_b16 v[60:61], v242 offset:28672
v_mfma_f32_16x16x32_bf16 v[156:159], v[16:19], a[72:75], v[156:159]
ds_read_b64_tr_b16 v[62:63], v242 offset:30720
v_mfma_f32_16x16x32_bf16 v[160:163], v[16:19], a[76:79], v[160:163]
v_mfma_f32_16x16x32_bf16 v[164:167], v[16:19], a[80:83], v[164:167]
ds_read_b64_tr_b16 v[64:65], v243 offset:24576
v_mfma_f32_16x16x32_bf16 v[140:143], v[20:23], a[84:87], v[140:143]
ds_read_b64_tr_b16 v[66:67], v243 offset:26624
s_add_u32 s52, s39, 0
v_mfma_f32_16x16x32_bf16 v[144:147], v[20:23], a[88:91], v[144:147]
buffer_store_dwordx4 v[36:39], v250, s[20:23], s52 offen offset:1024 sc1
v_mfma_f32_16x16x32_bf16 v[148:151], v[20:23], a[92:95], v[148:151]
ds_read_b64_tr_b16 v[68:69], v243 offset:28672
v_mfma_f32_16x16x32_bf16 v[152:155], v[20:23], a[96:99], v[152:155]
ds_read_b64_tr_b16 v[70:71], v243 offset:30720
v_mfma_f32_16x16x32_bf16 v[156:159], v[20:23], a[100:103], v[156:159]
v_mfma_f32_16x16x32_bf16 v[160:163], v[20:23], a[104:107], v[160:163]
ds_read_b64_tr_b16 v[72:73], v244 offset:24576
v_mfma_f32_16x16x32_bf16 v[164:167], v[20:23], a[108:111], v[164:167]
ds_read_b64_tr_b16 v[74:75], v244 offset:26624
s_add_u32 s52, s39, 0
v_mfma_f32_16x16x32_bf16 v[140:143], v[24:27], a[112:115], v[140:143]
buffer_store_dwordx4 v[40:43], v250, s[20:23], s52 offen offset:2048 sc1
v_mfma_f32_16x16x32_bf16 v[144:147], v[24:27], a[116:119], v[144:147]
ds_read_b64_tr_b16 v[76:77], v244 offset:28672
v_mfma_f32_16x16x32_bf16 v[148:151], v[24:27], a[120:123], v[148:151]
ds_read_b64_tr_b16 v[78:79], v244 offset:30720
v_mfma_f32_16x16x32_bf16 v[152:155], v[24:27], a[124:127], v[152:155]
v_mfma_f32_16x16x32_bf16 v[156:159], v[24:27], a[128:131], v[156:159]
ds_read_b64_tr_b16 v[80:81], v245 offset:24576
v_mfma_f32_16x16x32_bf16 v[160:163], v[24:27], a[132:135], v[160:163]
ds_read_b64_tr_b16 v[82:83], v245 offset:26624
v_mfma_f32_16x16x32_bf16 v[164:167], v[24:27], a[136:139], v[164:167]
v_mfma_f32_16x16x32_bf16 v[140:143], v[28:31], a[140:143], v[140:143]
ds_read_b64_tr_b16 v[84:85], v245 offset:28672
v_mfma_f32_16x16x32_bf16 v[144:147], v[28:31], a[144:147], v[144:147]
ds_read_b64_tr_b16 v[86:87], v245 offset:30720
v_mfma_f32_16x16x32_bf16 v[148:151], v[28:31], a[148:151], v[148:151]
v_mfma_f32_16x16x32_bf16 v[152:155], v[28:31], a[152:155], v[152:155]
v_mfma_f32_16x16x32_bf16 v[156:159], v[28:31], a[156:159], v[156:159]
v_mfma_f32_16x16x32_bf16 v[160:163], v[28:31], a[160:163], v[160:163]
v_mfma_f32_16x16x32_bf16 v[164:167], v[28:31], a[164:167], v[164:167]
s_waitcnt lgkmcnt(0)
v_mfma_f32_16x16x32_bf16 v[196:199], v[60:63], v[168:171], 0
s_add_u32 m0, s100, 8192
s_add_u32 s96, s96, 128
v_mfma_f32_16x16x32_bf16 v[200:203], v[60:63], v[172:175], 0
s_cmp_eq_u32 s96, s98
s_cselect_b32 s96, s97, s96
v_mfma_f32_16x16x32_bf16 v[204:207], v[60:63], v[176:179], 0
v_cvt_pk_bf16_f32 v88, v140, v141
v_mfma_f32_16x16x32_bf16 v[208:211], v[60:63], v[180:183], 0
buffer_load_dwordx4 v255, s[92:95], s96 offen offset:0  lds
v_mfma_f32_16x16x32_bf16 v[212:215], v[60:63], v[184:187], 0
v_cvt_pk_bf16_f32 v89, v142, v143
v_mfma_f32_16x16x32_bf16 v[216:219], v[60:63], v[188:191], 0
v_cvt_pk_bf16_f32 v90, v144, v145
v_mfma_f32_16x16x32_bf16 v[220:223], v[60:63], v[192:195], 0
buffer_load_dwordx4 v225, s[92:95], s96 offen offset:1024  lds
v_mfma_f32_16x16x32_bf16 v[196:199], v[56:59], v[112:115], v[196:199]
v_cvt_pk_bf16_f32 v91, v146, v147
v_mfma_f32_16x16x32_bf16 v[200:203], v[56:59], v[116:119], v[200:203]
v_cvt_pk_bf16_f32 v92, v148, v149
v_mfma_f32_16x16x32_bf16 v[204:207], v[56:59], v[120:123], v[204:207]
buffer_load_dwordx4 v226, s[92:95], s96 offen offset:2048  lds
v_mfma_f32_16x16x32_bf16 v[208:211], v[56:59], v[124:127], v[208:211]
v_cvt_pk_bf16_f32 v93, v150, v151
v_mfma_f32_16x16x32_bf16 v[212:215], v[56:59], v[128:131], v[212:215]
v_cvt_pk_bf16_f32 v94, v152, v153
v_mfma_f32_16x16x32_bf16 v[216:219], v[56:59], v[132:135], v[216:219]
buffer_load_dwordx4 v227, s[92:95], s96 offen offset:3072  lds
v_mfma_f32_16x16x32_bf16 v[220:223], v[56:59], v[136:139], v[220:223]
s_add_u32 m0, s100, 12288
v_mfma_f32_16x16x32_bf16 v[196:199], v[64:67], a[0:3], v[196:199]
s_add_u32 s51, s96, 36864
v_mfma_f32_16x16x32_bf16 v[200:203], v[64:67], a[4:7], v[200:203]
buffer_load_dwordx4 v255, s[92:95], s51 offen offset:0  lds
v_mfma_f32_16x16x32_bf16 v[204:207], v[64:67], a[8:11], v[204:207]
v_cvt_pk_bf16_f32 v95, v154, v155
v_mfma_f32_16x16x32_bf16 v[208:211], v[64:67], a[12:15], v[208:211]
v_cvt_pk_bf16_f32 v96, v156, v157
v_mfma_f32_16x16x32_bf16 v[212:215], v[64:67], a[16:19], v[212:215]
buffer_load_dwordx4 v225, s[92:95], s51 offen offset:1024  lds
v_mfma_f32_16x16x32_bf16 v[216:219], v[64:67], a[20:23], v[216:219]
v_cvt_pk_bf16_f32 v97, v158, v159
v_mfma_f32_16x16x32_bf16 v[220:223], v[64:67], a[24:27], v[220:223]
v_cvt_pk_bf16_f32 v98, v160, v161
v_mfma_f32_16x16x32_bf16 v[196:199], v[68:71], a[28:31], v[196:199]
buffer_load_dwordx4 v226, s[92:95], s51 offen offset:2048  lds
v_mfma_f32_16x16x32_bf16 v[200:203], v[68:71], a[32:35], v[200:203]
v_cvt_pk_bf16_f32 v99, v162, v163
v_mfma_f32_16x16x32_bf16 v[204:207], v[68:71], a[36:39], v[204:207]
v_cvt_pk_bf16_f32 v50, v164, v165
v_mfma_f32_16x16x32_bf16 v[208:211], v[68:71], a[40:43], v[208:211]
buffer_load_dwordx4 v227, s[92:95], s51 offen offset:3072  lds
v_mfma_f32_16x16x32_bf16 v[212:215], v[68:71], a[44:47], v[212:215]
v_cvt_pk_bf16_f32 v51, v166, v167
v_mfma_f32_16x16x32_bf16 v[216:219], v[68:71], a[48:51], v[216:219]
v_mfma_f32_16x16x32_bf16 v[220:223], v[68:71], a[52:55], v[220:223]
s_waitcnt vmcnt(19) lgkmcnt(0)
s_barrier
v_mfma_f32_16x16x32_bf16 v[196:199], v[72:75], a[56:59], v[196:199]
ds_read_b64_tr_b16 v[0:1], v246 offset:0
v_mfma_f32_16x16x32_bf16 v[200:203], v[72:75], a[60:63], v[200:203]
ds_read_b64_tr_b16 v[2:3], v246 offset:2048
s_add_u32 s52, s39, 0
v_mfma_f32_16x16x32_bf16 v[204:207], v[72:75], a[64:67], v[204:207]
buffer_store_dwordx4 v[88:91], v250, s[20:23], s52 offen offset:3072 sc1
v_mfma_f32_16x16x32_bf16 v[208:211], v[72:75], a[68:71], v[208:211]
ds_read_b64_tr_b16 v[4:5], v246 offset:4096
v_mfma_f32_16x16x32_bf16 v[212:215], v[72:75], a[72:75], v[212:215]
ds_read_b64_tr_b16 v[6:7], v246 offset:6144
v_mfma_f32_16x16x32_bf16 v[216:219], v[72:75], a[76:79], v[216:219]
v_mfma_f32_16x16x32_bf16 v[220:223], v[72:75], a[80:83], v[220:223]
ds_read_b64_tr_b16 v[8:9], v247 offset:0
v_mfma_f32_16x16x32_bf16 v[196:199], v[76:79], a[84:87], v[196:199]
ds_read_b64_tr_b16 v[10:11], v247 offset:2048
s_add_u32 s52, s39, 4096
v_mfma_f32_16x16x32_bf16 v[200:203], v[76:79], a[88:91], v[200:203]
buffer_store_dwordx4 v[92:95], v250, s[20:23], s52 offen offset:0 sc1
v_mfma_f32_16x16x32_bf16 v[204:207], v[76:79], a[92:95], v[204:207]
ds_read_b64_tr_b16 v[12:13], v247 offset:4096
v_mfma_f32_16x16x32_bf16 v[208:211], v[76:79], a[96:99], v[208:211]
ds_read_b64_tr_b16 v[14:15], v247 offset:6144
v_mfma_f32_16x16x32_bf16 v[212:215], v[76:79], a[100:103], v[212:215]
v_mfma_f32_16x16x32_bf16 v[216:219], v[76:79], a[104:107], v[216:219]
ds_read_b64_tr_b16 v[16:17], v248 offset:0
v_mfma_f32_16x16x32_bf16 v[220:223], v[76:79], a[108:111], v[220:223]
ds_read_b64_tr_b16 v[18:19], v248 offset:2048
s_add_u32 s52, s39, 4096
v_mfma_f32_16x16x32_bf16 v[196:199], v[80:83], a[112:115], v[196:199]
buffer_store_dwordx4 v[96:99], v250, s[20:23], s52 offen offset:1024 sc1
v_mfma_f32_16x16x32_bf16 v[200:203], v[80:83], a[116:119], v[200:203]
ds_read_b64_tr_b16 v[20:21], v248 offset:4096
v_mfma_f32_16x16x32_bf16 v[204:207], v[80:83], a[120:123], v[204:207]
ds_read_b64_tr_b16 v[22:23], v248 offset:6144
v_mfma_f32_16x16x32_bf16 v[208:211], v[80:83], a[124:127], v[208:211]
v_mfma_f32_16x16x32_bf16 v[212:215], v[80:83], a[128:131], v[212:215]
ds_read_b64_tr_b16 v[24:25], v249 offset:0
v_mfma_f32_16x16x32_bf16 v[216:219], v[80:83], a[132:135], v[216:219]
ds_read_b64_tr_b16 v[26:27], v249 offset:2048
s_add_u32 s52, s39, 24576
v_mfma_f32_16x16x32_bf16 v[220:223], v[80:83], a[136:139], v[220:223]
buffer_store_dwordx4 v[48:51], v250, s[20:23], s52 offen offset:3072 sc1
v_mfma_f32_16x16x32_bf16 v[196:199], v[84:87], a[140:143], v[196:199]
ds_read_b64_tr_b16 v[28:29], v249 offset:4096
v_mfma_f32_16x16x32_bf16 v[200:203], v[84:87], a[144:147], v[200:203]
ds_read_b64_tr_b16 v[30:31], v249 offset:6144
v_mfma_f32_16x16x32_bf16 v[204:207], v[84:87], a[148:151], v[204:207]
v_mfma_f32_16x16x32_bf16 v[208:211], v[84:87], a[152:155], v[208:211]
v_mfma_f32_16x16x32_bf16 v[212:215], v[84:87], a[156:159], v[212:215]
v_mfma_f32_16x16x32_bf16 v[216:219], v[84:87], a[160:163], v[216:219]
v_mfma_f32_16x16x32_bf16 v[220:223], v[84:87], a[164:167], v[220:223]
s_waitcnt lgkmcnt(0)
v_mfma_f32_16x16x32_bf16 v[140:143], v[4:7], v[168:171], 0
s_add_u32 m0, s100, 16384
s_add_u32 s96, s96, 128
v_mfma_f32_16x16x32_bf16 v[144:147], v[4:7], v[172:175], 0
s_cmp_eq_u32 s96, s98
s_cselect_b32 s96, s97, s96
v_mfma_f32_16x16x32_bf16 v[148:151], v[4:7], v[176:179], 0
v_cvt_pk_bf16_f32 v32, v196, v197
v_mfma_f32_16x16x32_bf16 v[152:155], v[4:7], v[180:183], 0
buffer_load_dwordx4 v255, s[92:95], s96 offen offset:0  lds
v_mfma_f32_16x16x32_bf16 v[156:159], v[4:7], v[184:187], 0
v_cvt_pk_bf16_f32 v33, v198, v199
v_mfma_f32_16x16x32_bf16 v[160:163], v[4:7], v[188:191], 0
v_cvt_pk_bf16_f32 v34, v200, v201
v_mfma_f32_16x16x32_bf16 v[164:167], v[4:7], v[192:195], 0
buffer_load_dwordx4 v225, s[92:95], s96 offen offset:1024  lds
v_mfma_f32_16x16x32_bf16 v[140:143], v[0:3], v[112:115], v[140:143]
v_cvt_pk_bf16_f32 v35, v202, v203
v_mfma_f32_16x16x32_bf16 v[144:147], v[0:3], v[116:119], v[144:147]
v_cvt_pk_bf16_f32 v36, v204, v205
v_mfma_f32_16x16x32_bf16 v[148:151], v[0:3], v[120:123], v[148:151]
buffer_load_dwordx4 v226, s[92:95], s96 offen offset:2048  lds
v_mfma_f32_16x16x32_bf16 v[152:155], v[0:3], v[124:127], v[152:155]
v_cvt_pk_bf16_f32 v37, v206, v207
v_mfma_f32_16x16x32_bf16 v[156:159], v[0:3], v[128:131], v[156:159]
v_cvt_pk_bf16_f32 v38, v208, v209
v_mfma_f32_16x16x32_bf16 v[160:163], v[0:3], v[132:135], v[160:163]
buffer_load_dwordx4 v227, s[92:95], s96 offen offset:3072  lds
v_mfma_f32_16x16x32_bf16 v[164:167], v[0:3], v[136:139], v[164:167]
s_add_u32 m0, s100, 20480
v_mfma_f32_16x16x32_bf16 v[140:143], v[8:11], a[0:3], v[140:143]
s_add_u32 s51, s96, 36864
v_mfma_f32_16x16x32_bf16 v[144:147], v[8:11], a[4:7], v[144:147]
buffer_load_dwordx4 v255, s[92:95], s51 offen offset:0  lds
v_mfma_f32_16x16x32_bf16 v[148:151], v[8:11], a[8:11], v[148:151]
v_cvt_pk_bf16_f32 v39, v210, v211
v_mfma_f32_16x16x32_bf16 v[152:155], v[8:11], a[12:15], v[152:155]
v_cvt_pk_bf16_f32 v40, v212, v213
v_mfma_f32_16x16x32_bf16 v[156:159], v[8:11], a[16:19], v[156:159]
buffer_load_dwordx4 v225, s[92:95], s51 offen offset:1024  lds
v_mfma_f32_16x16x32_bf16 v[160:163], v[8:11], a[20:23], v[160:163]
v_cvt_pk_bf16_f32 v41, v214, v215
v_mfma_f32_16x16x32_bf16 v[164:167], v[8:11], a[24:27], v[164:167]
v_cvt_pk_bf16_f32 v42, v216, v217
v_mfma_f32_16x16x32_bf16 v[140:143], v[12:15], a[28:31], v[140:143]
buffer_load_dwordx4 v226, s[92:95], s51 offen offset:2048  lds
v_mfma_f32_16x16x32_bf16 v[144:147], v[12:15], a[32:35], v[144:147]
v_cvt_pk_bf16_f32 v43, v218, v219
v_mfma_f32_16x16x32_bf16 v[148:151], v[12:15], a[36:39], v[148:151]
v_cvt_pk_bf16_f32 v52, v220, v221
v_mfma_f32_16x16x32_bf16 v[152:155], v[12:15], a[40:43], v[152:155]
buffer_load_dwordx4 v227, s[92:95], s51 offen offset:3072  lds
v_mfma_f32_16x16x32_bf16 v[156:159], v[12:15], a[44:47], v[156:159]
v_cvt_pk_bf16_f32 v53, v222, v223
v_mfma_f32_16x16x32_bf16 v[160:163], v[12:15], a[48:51], v[160:163]
v_mfma_f32_16x16x32_bf16 v[164:167], v[12:15], a[52:55], v[164:167]
s_waitcnt vmcnt(23) lgkmcnt(0)
s_barrier
v_mfma_f32_16x16x32_bf16 v[140:143], v[16:19], a[56:59], v[140:143]
ds_read_b64_tr_b16 v[56:57], v242 offset:0
v_mfma_f32_16x16x32_bf16 v[144:147], v[16:19], a[60:63], v[144:147]
ds_read_b64_tr_b16 v[58:59], v242 offset:2048
s_add_u32 s52, s39, 4096
v_mfma_f32_16x16x32_bf16 v[148:151], v[16:19], a[64:67], v[148:151]
buffer_store_dwordx4 v[32:35], v250, s[20:23], s52 offen offset:2048 sc1
v_mfma_f32_16x16x32_bf16 v[152:155], v[16:19], a[68:71], v[152:155]
ds_read_b64_tr_b16 v[60:61], v242 offset:4096
v_mfma_f32_16x16x32_bf16 v[156:159], v[16:19], a[72:75], v[156:159]
ds_read_b64_tr_b16 v[62:63], v242 offset:6144
v_mfma_f32_16x16x32_bf16 v[160:163], v[16:19], a[76:79], v[160:163]
v_mfma_f32_16x16x32_bf16 v[164:167], v[16:19], a[80:83], v[164:167]
ds_read_b64_tr_b16 v[64:65], v243 offset:0
v_mfma_f32_16x16x32_bf16 v[140:143], v[20:23], a[84:87], v[140:143]
ds_read_b64_tr_b16 v[66:67], v243 offset:2048
s_add_u32 s52, s39, 4096
v_mfma_f32_16x16x32_bf16 v[144:147], v[20:23], a[88:91], v[144:147]
buffer_store_dwordx4 v[36:39], v250, s[20:23], s52 offen offset:3072 sc1
v_mfma_f32_16x16x32_bf16 v[148:151], v[20:23], a[92:95], v[148:151]
ds_read_b64_tr_b16 v[68:69], v243 offset:4096
v_mfma_f32_16x16x32_bf16 v[152:155], v[20:23], a[96:99], v[152:155]
ds_read_b64_tr_b16 v[70:71], v243 offset:6144
v_mfma_f32_16x16x32_bf16 v[156:159], v[20:23], a[100:103], v[156:159]
v_mfma_f32_16x16x32_bf16 v[160:163], v[20:23], a[104:107], v[160:163]
ds_read_b64_tr_b16 v[72:73], v244 offset:0
v_mfma_f32_16x16x32_bf16 v[164:167], v[20:23], a[108:111], v[164:167]
ds_read_b64_tr_b16 v[74:75], v244 offset:2048
s_add_u32 s52, s39, 8192
v_mfma_f32_16x16x32_bf16 v[140:143], v[24:27], a[112:115], v[140:143]
buffer_store_dwordx4 v[40:43], v250, s[20:23], s52 offen offset:0 sc1
v_mfma_f32_16x16x32_bf16 v[144:147], v[24:27], a[116:119], v[144:147]
ds_read_b64_tr_b16 v[76:77], v244 offset:4096
v_mfma_f32_16x16x32_bf16 v[148:151], v[24:27], a[120:123], v[148:151]
ds_read_b64_tr_b16 v[78:79], v244 offset:6144
v_mfma_f32_16x16x32_bf16 v[152:155], v[24:27], a[124:127], v[152:155]
v_mfma_f32_16x16x32_bf16 v[156:159], v[24:27], a[128:131], v[156:159]
ds_read_b64_tr_b16 v[80:81], v245 offset:0
v_mfma_f32_16x16x32_bf16 v[160:163], v[24:27], a[132:135], v[160:163]
ds_read_b64_tr_b16 v[82:83], v245 offset:2048
v_mfma_f32_16x16x32_bf16 v[164:167], v[24:27], a[136:139], v[164:167]
v_mfma_f32_16x16x32_bf16 v[140:143], v[28:31], a[140:143], v[140:143]
ds_read_b64_tr_b16 v[84:85], v245 offset:4096
v_mfma_f32_16x16x32_bf16 v[144:147], v[28:31], a[144:147], v[144:147]
ds_read_b64_tr_b16 v[86:87], v245 offset:6144
v_mfma_f32_16x16x32_bf16 v[148:151], v[28:31], a[148:151], v[148:151]
v_mfma_f32_16x16x32_bf16 v[152:155], v[28:31], a[152:155], v[152:155]
v_mfma_f32_16x16x32_bf16 v[156:159], v[28:31], a[156:159], v[156:159]
v_mfma_f32_16x16x32_bf16 v[160:163], v[28:31], a[160:163], v[160:163]
v_mfma_f32_16x16x32_bf16 v[164:167], v[28:31], a[164:167], v[164:167]
s_waitcnt lgkmcnt(0)
v_mfma_f32_16x16x32_bf16 v[196:199], v[60:63], v[168:171], 0
s_add_u32 m0, s100, 24576
s_add_u32 s96, s96, 128
v_mfma_f32_16x16x32_bf16 v[200:203], v[60:63], v[172:175], 0
s_cmp_eq_u32 s96, s98
s_cselect_b32 s96, s97, s96
v_mfma_f32_16x16x32_bf16 v[204:207], v[60:63], v[176:179], 0
v_cvt_pk_bf16_f32 v88, v140, v141
v_mfma_f32_16x16x32_bf16 v[208:211], v[60:63], v[180:183], 0
buffer_load_dwordx4 v255, s[92:95], s96 offen offset:0  lds
v_mfma_f32_16x16x32_bf16 v[212:215], v[60:63], v[184:187], 0
v_cvt_pk_bf16_f32 v89, v142, v143
v_mfma_f32_16x16x32_bf16 v[216:219], v[60:63], v[188:191], 0
v_cvt_pk_bf16_f32 v90, v144, v145
v_mfma_f32_16x16x32_bf16 v[220:223], v[60:63], v[192:195], 0
buffer_load_dwordx4 v225, s[92:95], s96 offen offset:1024  lds
v_mfma_f32_16x16x32_bf16 v[196:199], v[56:59], v[112:115], v[196:199]
v_cvt_pk_bf16_f32 v91, v146, v147
v_mfma_f32_16x16x32_bf16 v[200:203], v[56:59], v[116:119], v[200:203]
v_cvt_pk_bf16_f32 v92, v148, v149
v_mfma_f32_16x16x32_bf16 v[204:207], v[56:59], v[120:123], v[204:207]
buffer_load_dwordx4 v226, s[92:95], s96 offen offset:2048  lds
v_mfma_f32_16x16x32_bf16 v[208:211], v[56:59], v[124:127], v[208:211]
v_cvt_pk_bf16_f32 v93, v150, v151
v_mfma_f32_16x16x32_bf16 v[212:215], v[56:59], v[128:131], v[212:215]
v_cvt_pk_bf16_f32 v94, v152, v153
v_mfma_f32_16x16x32_bf16 v[216:219], v[56:59], v[132:135], v[216:219]
buffer_load_dwordx4 v227, s[92:95], s96 offen offset:3072  lds
v_mfma_f32_16x16x32_bf16 v[220:223], v[56:59], v[136:139], v[220:223]
s_add_u32 m0, s100, 28672
v_mfma_f32_16x16x32_bf16 v[196:199], v[64:67], a[0:3], v[196:199]
s_add_u32 s51, s96, 36864
v_mfma_f32_16x16x32_bf16 v[200:203], v[64:67], a[4:7], v[200:203]
buffer_load_dwordx4 v255, s[92:95], s51 offen offset:0  lds
v_mfma_f32_16x16x32_bf16 v[204:207], v[64:67], a[8:11], v[204:207]
v_cvt_pk_bf16_f32 v95, v154, v155
v_mfma_f32_16x16x32_bf16 v[208:211], v[64:67], a[12:15], v[208:211]
v_cvt_pk_bf16_f32 v96, v156, v157
v_mfma_f32_16x16x32_bf16 v[212:215], v[64:67], a[16:19], v[212:215]
buffer_load_dwordx4 v225, s[92:95], s51 offen offset:1024  lds
v_mfma_f32_16x16x32_bf16 v[216:219], v[64:67], a[20:23], v[216:219]
v_cvt_pk_bf16_f32 v97, v158, v159
v_mfma_f32_16x16x32_bf16 v[220:223], v[64:67], a[24:27], v[220:223]
v_cvt_pk_bf16_f32 v98, v160, v161
v_mfma_f32_16x16x32_bf16 v[196:199], v[68:71], a[28:31], v[196:199]
buffer_load_dwordx4 v226, s[92:95], s51 offen offset:2048  lds
v_mfma_f32_16x16x32_bf16 v[200:203], v[68:71], a[32:35], v[200:203]
v_cvt_pk_bf16_f32 v99, v162, v163
v_mfma_f32_16x16x32_bf16 v[204:207], v[68:71], a[36:39], v[204:207]
v_cvt_pk_bf16_f32 v54, v164, v165
v_mfma_f32_16x16x32_bf16 v[208:211], v[68:71], a[40:43], v[208:211]
buffer_load_dwordx4 v227, s[92:95], s51 offen offset:3072  lds
v_mfma_f32_16x16x32_bf16 v[212:215], v[68:71], a[44:47], v[212:215]
v_cvt_pk_bf16_f32 v55, v166, v167
v_mfma_f32_16x16x32_bf16 v[216:219], v[68:71], a[48:51], v[216:219]
v_mfma_f32_16x16x32_bf16 v[220:223], v[68:71], a[52:55], v[220:223]
s_waitcnt vmcnt(23) lgkmcnt(0)
s_barrier
v_mfma_f32_16x16x32_bf16 v[196:199], v[72:75], a[56:59], v[196:199]
ds_read_b64_tr_b16 v[0:1], v242 offset:8192
v_mfma_f32_16x16x32_bf16 v[200:203], v[72:75], a[60:63], v[200:203]
ds_read_b64_tr_b16 v[2:3], v242 offset:10240
s_add_u32 s52, s39, 8192
v_mfma_f32_16x16x32_bf16 v[204:207], v[72:75], a[64:67], v[204:207]
buffer_store_dwordx4 v[88:91], v250, s[20:23], s52 offen offset:1024 sc1
v_mfma_f32_16x16x32_bf16 v[208:211], v[72:75], a[68:71], v[208:211]
ds_read_b64_tr_b16 v[4:5], v242 offset:12288
v_mfma_f32_16x16x32_bf16 v[212:215], v[72:75], a[72:75], v[212:215]
ds_read_b64_tr_b16 v[6:7], v242 offset:14336
v_mfma_f32_16x16x32_bf16 v[216:219], v[72:75], a[76:79], v[216:219]
v_mfma_f32_16x16x32_bf16 v[220:223], v[72:75], a[80:83], v[220:223]
ds_read_b64_tr_b16 v[8:9], v243 offset:8192
v_mfma_f32_16x16x32_bf16 v[196:199], v[76:79], a[84:87], v[196:199]
ds_read_b64_tr_b16 v[10:11], v243 offset:10240
s_add_u32 s52, s39, 8192
v_mfma_f32_16x16x32_bf16 v[200:203], v[76:79], a[88:91], v[200:203]
buffer_store_dwordx4 v[92:95], v250, s[20:23], s52 offen offset:2048 sc1
v_mfma_f32_16x16x32_bf16 v[204:207], v[76:79], a[92:95], v[204:207]
ds_read_b64_tr_b16 v[12:13], v243 offset:12288
v_mfma_f32_16x16x32_bf16 v[208:211], v[76:79], a[96:99], v[208:211]
ds_read_b64_tr_b16 v[14:15], v243 offset:14336
v_mfma_f32_16x16x32_bf16 v[212:215], v[76:79], a[100:103], v[212:215]
v_mfma_f32_16x16x32_bf16 v[216:219], v[76:79], a[104:107], v[216:219]
ds_read_b64_tr_b16 v[16:17], v244 offset:8192
v_mfma_f32_16x16x32_bf16 v[220:223], v[76:79], a[108:111], v[220:223]
ds_read_b64_tr_b16 v[18:19], v244 offset:10240
s_add_u32 s52, s39, 8192
v_mfma_f32_16x16x32_bf16 v[196:199], v[80:83], a[112:115], v[196:199]
buffer_store_dwordx4 v[96:99], v250, s[20:23], s52 offen offset:3072 sc1
v_mfma_f32_16x16x32_bf16 v[200:203], v[80:83], a[116:119], v[200:203]
ds_read_b64_tr_b16 v[20:21], v244 offset:12288
v_mfma_f32_16x16x32_bf16 v[204:207], v[80:83], a[120:123], v[204:207]
ds_read_b64_tr_b16 v[22:23], v244 offset:14336
v_mfma_f32_16x16x32_bf16 v[208:211], v[80:83], a[124:127], v[208:211]
v_mfma_f32_16x16x32_bf16 v[212:215], v[80:83], a[128:131], v[212:215]
ds_read_b64_tr_b16 v[24:25], v245 offset:8192
v_mfma_f32_16x16x32_bf16 v[216:219], v[80:83], a[132:135], v[216:219]
ds_read_b64_tr_b16 v[26:27], v245 offset:10240
s_add_u32 s52, s39, 28672
v_mfma_f32_16x16x32_bf16 v[220:223], v[80:83], a[136:139], v[220:223]
buffer_store_dwordx4 v[52:55], v250, s[20:23], s52 offen offset:0 sc1
v_mfma_f32_16x16x32_bf16 v[196:199], v[84:87], a[140:143], v[196:199]
ds_read_b64_tr_b16 v[28:29], v245 offset:12288
v_mfma_f32_16x16x32_bf16 v[200:203], v[84:87], a[144:147], v[200:203]
ds_read_b64_tr_b16 v[30:31], v245 offset:14336
v_mfma_f32_16x16x32_bf16 v[204:207], v[84:87], a[148:151], v[204:207]
v_mfma_f32_16x16x32_bf16 v[208:211], v[84:87], a[152:155], v[208:211]
v_mfma_f32_16x16x32_bf16 v[212:215], v[84:87], a[156:159], v[212:215]
v_mfma_f32_16x16x32_bf16 v[216:219], v[84:87], a[160:163], v[216:219]
v_mfma_f32_16x16x32_bf16 v[220:223], v[84:87], a[164:167], v[220:223]
s_waitcnt lgkmcnt(0)
v_mfma_f32_16x16x32_bf16 v[140:143], v[4:7], v[168:171], 0
s_add_u32 m0, s99, 0
s_add_u32 s96, s96, 128
v_mfma_f32_16x16x32_bf16 v[144:147], v[4:7], v[172:175], 0
s_cmp_eq_u32 s96, s98
s_cselect_b32 s96, s97, s96
v_mfma_f32_16x16x32_bf16 v[148:151], v[4:7], v[176:179], 0
v_cvt_pk_bf16_f32 v32, v196, v197
v_mfma_f32_16x16x32_bf16 v[152:155], v[4:7], v[180:183], 0
buffer_load_dwordx4 v255, s[92:95], s96 offen offset:0  lds
v_mfma_f32_16x16x32_bf16 v[156:159], v[4:7], v[184:187], 0
v_cvt_pk_bf16_f32 v33, v198, v199
v_mfma_f32_16x16x32_bf16 v[160:163], v[4:7], v[188:191], 0
v_cvt_pk_bf16_f32 v34, v200, v201
v_mfma_f32_16x16x32_bf16 v[164:167], v[4:7], v[192:195], 0
buffer_load_dwordx4 v225, s[92:95], s96 offen offset:1024  lds
v_mfma_f32_16x16x32_bf16 v[140:143], v[0:3], v[112:115], v[140:143]
v_cvt_pk_bf16_f32 v35, v202, v203
v_mfma_f32_16x16x32_bf16 v[144:147], v[0:3], v[116:119], v[144:147]
v_cvt_pk_bf16_f32 v36, v204, v205
v_mfma_f32_16x16x32_bf16 v[148:151], v[0:3], v[120:123], v[148:151]
buffer_load_dwordx4 v226, s[92:95], s96 offen offset:2048  lds
v_mfma_f32_16x16x32_bf16 v[152:155], v[0:3], v[124:127], v[152:155]
v_cvt_pk_bf16_f32 v37, v206, v207
v_mfma_f32_16x16x32_bf16 v[156:159], v[0:3], v[128:131], v[156:159]
v_cvt_pk_bf16_f32 v38, v208, v209
v_mfma_f32_16x16x32_bf16 v[160:163], v[0:3], v[132:135], v[160:163]
buffer_load_dwordx4 v227, s[92:95], s96 offen offset:3072  lds
v_mfma_f32_16x16x32_bf16 v[164:167], v[0:3], v[136:139], v[164:167]
s_add_u32 m0, s99, 4096
v_mfma_f32_16x16x32_bf16 v[140:143], v[8:11], a[0:3], v[140:143]
s_add_u32 s51, s96, 36864
v_mfma_f32_16x16x32_bf16 v[144:147], v[8:11], a[4:7], v[144:147]
buffer_load_dwordx4 v255, s[92:95], s51 offen offset:0  lds
v_mfma_f32_16x16x32_bf16 v[148:151], v[8:11], a[8:11], v[148:151]
v_cvt_pk_bf16_f32 v39, v210, v211
v_mfma_f32_16x16x32_bf16 v[152:155], v[8:11], a[12:15], v[152:155]
v_cvt_pk_bf16_f32 v40, v212, v213
v_mfma_f32_16x16x32_bf16 v[156:159], v[8:11], a[16:19], v[156:159]
buffer_load_dwordx4 v225, s[92:95], s51 offen offset:1024  lds
v_mfma_f32_16x16x32_bf16 v[160:163], v[8:11], a[20:23], v[160:163]
v_cvt_pk_bf16_f32 v41, v214, v215
v_mfma_f32_16x16x32_bf16 v[164:167], v[8:11], a[24:27], v[164:167]
v_cvt_pk_bf16_f32 v42, v216, v217
v_mfma_f32_16x16x32_bf16 v[140:143], v[12:15], a[28:31], v[140:143]
buffer_load_dwordx4 v226, s[92:95], s51 offen offset:2048  lds
v_mfma_f32_16x16x32_bf16 v[144:147], v[12:15], a[32:35], v[144:147]
v_cvt_pk_bf16_f32 v43, v218, v219
v_mfma_f32_16x16x32_bf16 v[148:151], v[12:15], a[36:39], v[148:151]
v_cvt_pk_bf16_f32 v48, v220, v221
v_mfma_f32_16x16x32_bf16 v[152:155], v[12:15], a[40:43], v[152:155]
buffer_load_dwordx4 v227, s[92:95], s51 offen offset:3072  lds
v_mfma_f32_16x16x32_bf16 v[156:159], v[12:15], a[44:47], v[156:159]
v_cvt_pk_bf16_f32 v49, v222, v223
v_mfma_f32_16x16x32_bf16 v[160:163], v[12:15], a[48:51], v[160:163]
v_mfma_f32_16x16x32_bf16 v[164:167], v[12:15], a[52:55], v[164:167]
s_waitcnt vmcnt(23) lgkmcnt(0)
s_barrier
v_mfma_f32_16x16x32_bf16 v[140:143], v[16:19], a[56:59], v[140:143]
ds_read_b64_tr_b16 v[56:57], v242 offset:16384
v_mfma_f32_16x16x32_bf16 v[144:147], v[16:19], a[60:63], v[144:147]
ds_read_b64_tr_b16 v[58:59], v242 offset:18432
s_add_u32 s52, s39, 12288
v_mfma_f32_16x16x32_bf16 v[148:151], v[16:19], a[64:67], v[148:151]
buffer_store_dwordx4 v[32:35], v250, s[20:23], s52 offen offset:0 sc1
v_mfma_f32_16x16x32_bf16 v[152:155], v[16:19], a[68:71], v[152:155]
ds_read_b64_tr_b16 v[60:61], v242 offset:20480
v_mfma_f32_16x16x32_bf16 v[156:159], v[16:19], a[72:75], v[156:159]
ds_read_b64_tr_b16 v[62:63], v242 offset:22528
v_mfma_f32_16x16x32_bf16 v[160:163], v[16:19], a[76:79], v[160:163]
v_mfma_f32_16x16x32_bf16 v[164:167], v[16:19], a[80:83], v[164:167]
ds_read_b64_tr_b16 v[64:65], v243 offset:16384
v_mfma_f32_16x16x32_bf16 v[140:143], v[20:23], a[84:87], v[140:143]
ds_read_b64_tr_b16 v[66:67], v243 offset:18432
s_add_u32 s52, s39, 12288
v_mfma_f32_16x16x32_bf16 v[144:147], v[20:23], a[88:91], v[144:147]
buffer_store_dwordx4 v[36:39], v250, s[20:23], s52 offen offset:1024 sc1
v_mfma_f32_16x16x32_bf16 v[148:151], v[20:23], a[92:95], v[148:151]
ds_read_b64_tr_b16 v[68:69], v243 offset:20480
v_mfma_f32_16x16x32_bf16 v[152:155], v[20:23], a[96:99], v[152:155]
ds_read_b64_tr_b16 v[70:71], v243 offset:22528
v_mfma_f32_16x16x32_bf16 v[156:159], v[20:23], a[100:103], v[156:159]
v_mfma_f32_16x16x32_bf16 v[160:163], v[20:23], a[104:107], v[160:163]
ds_read_b64_tr_b16 v[72:73], v244 offset:16384
v_mfma_f32_16x16x32_bf16 v[164:167], v[20:23], a[108:111], v[164:167]
ds_read_b64_tr_b16 v[74:75], v244 offset:18432
s_add_u32 s52, s39, 12288
v_mfma_f32_16x16x32_bf16 v[140:143], v[24:27], a[112:115], v[140:143]
buffer_store_dwordx4 v[40:43], v250, s[20:23], s52 offen offset:2048 sc1
v_mfma_f32_16x16x32_bf16 v[144:147], v[24:27], a[116:119], v[144:147]
ds_read_b64_tr_b16 v[76:77], v244 offset:20480
v_mfma_f32_16x16x32_bf16 v[148:151], v[24:27], a[120:123], v[148:151]
ds_read_b64_tr_b16 v[78:79], v244 offset:22528
v_mfma_f32_16x16x32_bf16 v[152:155], v[24:27], a[124:127], v[152:155]
v_mfma_f32_16x16x32_bf16 v[156:159], v[24:27], a[128:131], v[156:159]
ds_read_b64_tr_b16 v[80:81], v245 offset:16384
v_mfma_f32_16x16x32_bf16 v[160:163], v[24:27], a[132:135], v[160:163]
ds_read_b64_tr_b16 v[82:83], v245 offset:18432
v_mfma_f32_16x16x32_bf16 v[164:167], v[24:27], a[136:139], v[164:167]
v_mfma_f32_16x16x32_bf16 v[140:143], v[28:31], a[140:143], v[140:143]
ds_read_b64_tr_b16 v[84:85], v245 offset:20480
v_mfma_f32_16x16x32_bf16 v[144:147], v[28:31], a[144:147], v[144:147]
ds_read_b64_tr_b16 v[86:87], v245 offset:22528
v_mfma_f32_16x16x32_bf16 v[148:151], v[28:31], a[148:151], v[148:151]
v_mfma_f32_16x16x32_bf16 v[152:155], v[28:31], a[152:155], v[152:155]
v_mfma_f32_16x16x32_bf16 v[156:159], v[28:31], a[156:159], v[156:159]
v_mfma_f32_16x16x32_bf16 v[160:163], v[28:31], a[160:163], v[160:163]
v_mfma_f32_16x16x32_bf16 v[164:167], v[28:31], a[164:167], v[164:167]
s_waitcnt lgkmcnt(0)
v_mfma_f32_16x16x32_bf16 v[196:199], v[60:63], v[168:171], 0
v_mfma_f32_16x16x32_bf16 v[200:203], v[60:63], v[172:175], 0
v_mfma_f32_16x16x32_bf16 v[204:207], v[60:63], v[176:179], 0
v_cvt_pk_bf16_f32 v88, v140, v141
v_mfma_f32_16x16x32_bf16 v[208:211], v[60:63], v[180:183], 0
v_mfma_f32_16x16x32_bf16 v[212:215], v[60:63], v[184:187], 0
v_cvt_pk_bf16_f32 v89, v142, v143
v_mfma_f32_16x16x32_bf16 v[216:219], v[60:63], v[188:191], 0
v_cvt_pk_bf16_f32 v90, v144, v145
v_mfma_f32_16x16x32_bf16 v[220:223], v[60:63], v[192:195], 0
v_mfma_f32_16x16x32_bf16 v[196:199], v[56:59], v[112:115], v[196:199]
v_cvt_pk_bf16_f32 v91, v146, v147
v_mfma_f32_16x16x32_bf16 v[200:203], v[56:59], v[116:119], v[200:203]
v_cvt_pk_bf16_f32 v92, v148, v149
v_mfma_f32_16x16x32_bf16 v[204:207], v[56:59], v[120:123], v[204:207]
v_mfma_f32_16x16x32_bf16 v[208:211], v[56:59], v[124:127], v[208:211]
v_cvt_pk_bf16_f32 v93, v150, v151
v_mfma_f32_16x16x32_bf16 v[212:215], v[56:59], v[128:131], v[212:215]
v_cvt_pk_bf16_f32 v94, v152, v153
v_mfma_f32_16x16x32_bf16 v[216:219], v[56:59], v[132:135], v[216:219]
v_mfma_f32_16x16x32_bf16 v[220:223], v[56:59], v[136:139], v[220:223]
v_mfma_f32_16x16x32_bf16 v[196:199], v[64:67], a[0:3], v[196:199]
v_mfma_f32_16x16x32_bf16 v[200:203], v[64:67], a[4:7], v[200:203]
v_mfma_f32_16x16x32_bf16 v[204:207], v[64:67], a[8:11], v[204:207]
v_cvt_pk_bf16_f32 v95, v154, v155
v_mfma_f32_16x16x32_bf16 v[208:211], v[64:67], a[12:15], v[208:211]
v_cvt_pk_bf16_f32 v96, v156, v157
v_mfma_f32_16x16x32_bf16 v[212:215], v[64:67], a[16:19], v[212:215]
v_mfma_f32_16x16x32_bf16 v[216:219], v[64:67], a[20:23], v[216:219]
v_cvt_pk_bf16_f32 v97, v158, v159
v_mfma_f32_16x16x32_bf16 v[220:223], v[64:67], a[24:27], v[220:223]
v_cvt_pk_bf16_f32 v98, v160, v161
v_mfma_f32_16x16x32_bf16 v[196:199], v[68:71], a[28:31], v[196:199]
v_mfma_f32_16x16x32_bf16 v[200:203], v[68:71], a[32:35], v[200:203]
v_cvt_pk_bf16_f32 v99, v162, v163
v_mfma_f32_16x16x32_bf16 v[204:207], v[68:71], a[36:39], v[204:207]
v_cvt_pk_bf16_f32 v50, v164, v165
v_mfma_f32_16x16x32_bf16 v[208:211], v[68:71], a[40:43], v[208:211]
v_mfma_f32_16x16x32_bf16 v[212:215], v[68:71], a[44:47], v[212:215]
v_cvt_pk_bf16_f32 v51, v166, v167
v_mfma_f32_16x16x32_bf16 v[216:219], v[68:71], a[48:51], v[216:219]
v_mfma_f32_16x16x32_bf16 v[220:223], v[68:71], a[52:55], v[220:223]
s_waitcnt vmcnt(15) lgkmcnt(0)
s_barrier
v_mfma_f32_16x16x32_bf16 v[196:199], v[72:75], a[56:59], v[196:199]
ds_read_b64_tr_b16 v[0:1], v242 offset:24576
v_mfma_f32_16x16x32_bf16 v[200:203], v[72:75], a[60:63], v[200:203]
ds_read_b64_tr_b16 v[2:3], v242 offset:26624
s_add_u32 s52, s39, 12288
v_mfma_f32_16x16x32_bf16 v[204:207], v[72:75], a[64:67], v[204:207]
buffer_store_dwordx4 v[88:91], v250, s[20:23], s52 offen offset:3072 sc1
v_mfma_f32_16x16x32_bf16 v[208:211], v[72:75], a[68:71], v[208:211]
ds_read_b64_tr_b16 v[4:5], v242 offset:28672
v_mfma_f32_16x16x32_bf16 v[212:215], v[72:75], a[72:75], v[212:215]
ds_read_b64_tr_b16 v[6:7], v242 offset:30720
v_mfma_f32_16x16x32_bf16 v[216:219], v[72:75], a[76:79], v[216:219]
v_mfma_f32_16x16x32_bf16 v[220:223], v[72:75], a[80:83], v[220:223]
ds_read_b64_tr_b16 v[8:9], v243 offset:24576
v_mfma_f32_16x16x32_bf16 v[196:199], v[76:79], a[84:87], v[196:199]
ds_read_b64_tr_b16 v[10:11], v243 offset:26624
s_add_u32 s52, s39, 16384
v_mfma_f32_16x16x32_bf16 v[200:203], v[76:79], a[88:91], v[200:203]
buffer_store_dwordx4 v[92:95], v250, s[20:23], s52 offen offset:0 sc1
v_mfma_f32_16x16x32_bf16 v[204:207], v[76:79], a[92:95], v[204:207]
ds_read_b64_tr_b16 v[12:13], v243 offset:28672
v_mfma_f32_16x16x32_bf16 v[208:211], v[76:79], a[96:99], v[208:211]
ds_read_b64_tr_b16 v[14:15], v243 offset:30720
v_mfma_f32_16x16x32_bf16 v[212:215], v[76:79], a[100:103], v[212:215]
v_mfma_f32_16x16x32_bf16 v[216:219], v[76:79], a[104:107], v[216:219]
ds_read_b64_tr_b16 v[16:17], v244 offset:24576
v_mfma_f32_16x16x32_bf16 v[220:223], v[76:79], a[108:111], v[220:223]
ds_read_b64_tr_b16 v[18:19], v244 offset:26624
s_add_u32 s52, s39, 16384
v_mfma_f32_16x16x32_bf16 v[196:199], v[80:83], a[112:115], v[196:199]
buffer_store_dwordx4 v[96:99], v250, s[20:23], s52 offen offset:1024 sc1
v_mfma_f32_16x16x32_bf16 v[200:203], v[80:83], a[116:119], v[200:203]
ds_read_b64_tr_b16 v[20:21], v244 offset:28672
v_mfma_f32_16x16x32_bf16 v[204:207], v[80:83], a[120:123], v[204:207]
ds_read_b64_tr_b16 v[22:23], v244 offset:30720
v_mfma_f32_16x16x32_bf16 v[208:211], v[80:83], a[124:127], v[208:211]
v_mfma_f32_16x16x32_bf16 v[212:215], v[80:83], a[128:131], v[212:215]
ds_read_b64_tr_b16 v[24:25], v245 offset:24576
v_mfma_f32_16x16x32_bf16 v[216:219], v[80:83], a[132:135], v[216:219]
ds_read_b64_tr_b16 v[26:27], v245 offset:26624
s_add_u32 s52, s39, 28672
v_mfma_f32_16x16x32_bf16 v[220:223], v[80:83], a[136:139], v[220:223]
buffer_store_dwordx4 v[48:51], v250, s[20:23], s52 offen offset:1024 sc1
v_mfma_f32_16x16x32_bf16 v[196:199], v[84:87], a[140:143], v[196:199]
ds_read_b64_tr_b16 v[28:29], v245 offset:28672
v_mfma_f32_16x16x32_bf16 v[200:203], v[84:87], a[144:147], v[200:203]
ds_read_b64_tr_b16 v[30:31], v245 offset:30720
v_mfma_f32_16x16x32_bf16 v[204:207], v[84:87], a[148:151], v[204:207]
v_mfma_f32_16x16x32_bf16 v[208:211], v[84:87], a[152:155], v[208:211]
v_mfma_f32_16x16x32_bf16 v[212:215], v[84:87], a[156:159], v[212:215]
v_mfma_f32_16x16x32_bf16 v[216:219], v[84:87], a[160:163], v[216:219]
v_mfma_f32_16x16x32_bf16 v[220:223], v[84:87], a[164:167], v[220:223]
s_waitcnt lgkmcnt(0)
v_mfma_f32_16x16x32_bf16 v[140:143], v[4:7], v[168:171], 0
v_mfma_f32_16x16x32_bf16 v[144:147], v[4:7], v[172:175], 0
v_mfma_f32_16x16x32_bf16 v[148:151], v[4:7], v[176:179], 0
v_cvt_pk_bf16_f32 v32, v196, v197
v_mfma_f32_16x16x32_bf16 v[152:155], v[4:7], v[180:183], 0
v_mfma_f32_16x16x32_bf16 v[156:159], v[4:7], v[184:187], 0
v_cvt_pk_bf16_f32 v33, v198, v199
v_mfma_f32_16x16x32_bf16 v[160:163], v[4:7], v[188:191], 0
v_cvt_pk_bf16_f32 v34, v200, v201
v_mfma_f32_16x16x32_bf16 v[164:167], v[4:7], v[192:195], 0
v_mfma_f32_16x16x32_bf16 v[140:143], v[0:3], v[112:115], v[140:143]
v_cvt_pk_bf16_f32 v35, v202, v203
v_mfma_f32_16x16x32_bf16 v[144:147], v[0:3], v[116:119], v[144:147]
v_cvt_pk_bf16_f32 v36, v204, v205
v_mfma_f32_16x16x32_bf16 v[148:151], v[0:3], v[120:123], v[148:151]
v_mfma_f32_16x16x32_bf16 v[152:155], v[0:3], v[124:127], v[152:155]
v_cvt_pk_bf16_f32 v37, v206, v207
v_mfma_f32_16x16x32_bf16 v[156:159], v[0:3], v[128:131], v[156:159]
v_cvt_pk_bf16_f32 v38, v208, v209
v_mfma_f32_16x16x32_bf16 v[160:163], v[0:3], v[132:135], v[160:163]
v_mfma_f32_16x16x32_bf16 v[164:167], v[0:3], v[136:139], v[164:167]
v_mfma_f32_16x16x32_bf16 v[140:143], v[8:11], a[0:3], v[140:143]
v_mfma_f32_16x16x32_bf16 v[144:147], v[8:11], a[4:7], v[144:147]
v_mfma_f32_16x16x32_bf16 v[148:151], v[8:11], a[8:11], v[148:151]
v_cvt_pk_bf16_f32 v39, v210, v211
v_mfma_f32_16x16x32_bf16 v[152:155], v[8:11], a[12:15], v[152:155]
v_cvt_pk_bf16_f32 v40, v212, v213
v_mfma_f32_16x16x32_bf16 v[156:159], v[8:11], a[16:19], v[156:159]
v_mfma_f32_16x16x32_bf16 v[160:163], v[8:11], a[20:23], v[160:163]
v_cvt_pk_bf16_f32 v41, v214, v215
v_mfma_f32_16x16x32_bf16 v[164:167], v[8:11], a[24:27], v[164:167]
v_cvt_pk_bf16_f32 v42, v216, v217
v_mfma_f32_16x16x32_bf16 v[140:143], v[12:15], a[28:31], v[140:143]
v_mfma_f32_16x16x32_bf16 v[144:147], v[12:15], a[32:35], v[144:147]
v_cvt_pk_bf16_f32 v43, v218, v219
v_mfma_f32_16x16x32_bf16 v[148:151], v[12:15], a[36:39], v[148:151]
v_cvt_pk_bf16_f32 v52, v220, v221
v_mfma_f32_16x16x32_bf16 v[152:155], v[12:15], a[40:43], v[152:155]
v_mfma_f32_16x16x32_bf16 v[156:159], v[12:15], a[44:47], v[156:159]
v_cvt_pk_bf16_f32 v53, v222, v223
v_mfma_f32_16x16x32_bf16 v[160:163], v[12:15], a[48:51], v[160:163]
v_mfma_f32_16x16x32_bf16 v[164:167], v[12:15], a[52:55], v[164:167]
s_waitcnt vmcnt(7) lgkmcnt(0)
s_barrier
v_mfma_f32_16x16x32_bf16 v[140:143], v[16:19], a[56:59], v[140:143]
ds_read_b64_tr_b16 v[56:57], v246 offset:0
v_mfma_f32_16x16x32_bf16 v[144:147], v[16:19], a[60:63], v[144:147]
ds_read_b64_tr_b16 v[58:59], v246 offset:2048
s_add_u32 s52, s39, 16384
v_mfma_f32_16x16x32_bf16 v[148:151], v[16:19], a[64:67], v[148:151]
buffer_store_dwordx4 v[32:35], v250, s[20:23], s52 offen offset:2048 sc1
v_mfma_f32_16x16x32_bf16 v[152:155], v[16:19], a[68:71], v[152:155]
ds_read_b64_tr_b16 v[60:61], v246 offset:4096
v_mfma_f32_16x16x32_bf16 v[156:159], v[16:19], a[72:75], v[156:159]
ds_read_b64_tr_b16 v[62:63], v246 offset:6144
v_mfma_f32_16x16x32_bf16 v[160:163], v[16:19], a[76:79], v[160:163]
v_mfma_f32_16x16x32_bf16 v[164:167], v[16:19], a[80:83], v[164:167]
ds_read_b64_tr_b16 v[64:65], v247 offset:0
v_mfma_f32_16x16x32_bf16 v[140:143], v[20:23], a[84:87], v[140:143]
ds_read_b64_tr_b16 v[66:67], v247 offset:2048
s_add_u32 s52, s39, 16384
v_mfma_f32_16x16x32_bf16 v[144:147], v[20:23], a[88:91], v[144:147]
buffer_store_dwordx4 v[36:39], v250, s[20:23], s52 offen offset:3072 sc1
v_mfma_f32_16x16x32_bf16 v[148:151], v[20:23], a[92:95], v[148:151]
ds_read_b64_tr_b16 v[68:69], v247 offset:4096
v_mfma_f32_16x16x32_bf16 v[152:155], v[20:23], a[96:99], v[152:155]
ds_read_b64_tr_b16 v[70:71], v247 offset:6144
v_mfma_f32_16x16x32_bf16 v[156:159], v[20:23], a[100:103], v[156:159]
v_mfma_f32_16x16x32_bf16 v[160:163], v[20:23], a[104:107], v[160:163]
ds_read_b64_tr_b16 v[72:73], v248 offset:0
v_mfma_f32_16x16x32_bf16 v[164:167], v[20:23], a[108:111], v[164:167]
ds_read_b64_tr_b16 v[74:75], v248 offset:2048
s_add_u32 s52, s39, 20480
v_mfma_f32_16x16x32_bf16 v[140:143], v[24:27], a[112:115], v[140:143]
buffer_store_dwordx4 v[40:43], v250, s[20:23], s52 offen offset:0 sc1
v_mfma_f32_16x16x32_bf16 v[144:147], v[24:27], a[116:119], v[144:147]
ds_read_b64_tr_b16 v[76:77], v248 offset:4096
v_mfma_f32_16x16x32_bf16 v[148:151], v[24:27], a[120:123], v[148:151]
ds_read_b64_tr_b16 v[78:79], v248 offset:6144
v_mfma_f32_16x16x32_bf16 v[152:155], v[24:27], a[124:127], v[152:155]
v_mfma_f32_16x16x32_bf16 v[156:159], v[24:27], a[128:131], v[156:159]
ds_read_b64_tr_b16 v[80:81], v249 offset:0
v_mfma_f32_16x16x32_bf16 v[160:163], v[24:27], a[132:135], v[160:163]
ds_read_b64_tr_b16 v[82:83], v249 offset:2048
v_mfma_f32_16x16x32_bf16 v[164:167], v[24:27], a[136:139], v[164:167]
v_mfma_f32_16x16x32_bf16 v[140:143], v[28:31], a[140:143], v[140:143]
ds_read_b64_tr_b16 v[84:85], v249 offset:4096
v_mfma_f32_16x16x32_bf16 v[144:147], v[28:31], a[144:147], v[144:147]
ds_read_b64_tr_b16 v[86:87], v249 offset:6144
v_mfma_f32_16x16x32_bf16 v[148:151], v[28:31], a[148:151], v[148:151]
v_mfma_f32_16x16x32_bf16 v[152:155], v[28:31], a[152:155], v[152:155]
v_mfma_f32_16x16x32_bf16 v[156:159], v[28:31], a[156:159], v[156:159]
v_mfma_f32_16x16x32_bf16 v[160:163], v[28:31], a[160:163], v[160:163]
v_mfma_f32_16x16x32_bf16 v[164:167], v[28:31], a[164:167], v[164:167]
s_waitcnt lgkmcnt(0)
v_mfma_f32_16x16x32_bf16 v[196:199], v[60:63], v[168:171], 0
v_mfma_f32_16x16x32_bf16 v[200:203], v[60:63], v[172:175], 0
v_mfma_f32_16x16x32_bf16 v[204:207], v[60:63], v[176:179], 0
v_cvt_pk_bf16_f32 v88, v140, v141
v_mfma_f32_16x16x32_bf16 v[208:211], v[60:63], v[180:183], 0
v_mfma_f32_16x16x32_bf16 v[212:215], v[60:63], v[184:187], 0
v_cvt_pk_bf16_f32 v89, v142, v143
v_mfma_f32_16x16x32_bf16 v[216:219], v[60:63], v[188:191], 0
v_cvt_pk_bf16_f32 v90, v144, v145
v_mfma_f32_16x16x32_bf16 v[220:223], v[60:63], v[192:195], 0
v_mfma_f32_16x16x32_bf16 v[196:199], v[56:59], v[112:115], v[196:199]
v_cvt_pk_bf16_f32 v91, v146, v147
v_mfma_f32_16x16x32_bf16 v[200:203], v[56:59], v[116:119], v[200:203]
v_cvt_pk_bf16_f32 v92, v148, v149
v_mfma_f32_16x16x32_bf16 v[204:207], v[56:59], v[120:123], v[204:207]
v_mfma_f32_16x16x32_bf16 v[208:211], v[56:59], v[124:127], v[208:211]
v_cvt_pk_bf16_f32 v93, v150, v151
v_mfma_f32_16x16x32_bf16 v[212:215], v[56:59], v[128:131], v[212:215]
v_cvt_pk_bf16_f32 v94, v152, v153
v_mfma_f32_16x16x32_bf16 v[216:219], v[56:59], v[132:135], v[216:219]
v_mfma_f32_16x16x32_bf16 v[220:223], v[56:59], v[136:139], v[220:223]
v_mfma_f32_16x16x32_bf16 v[196:199], v[64:67], a[0:3], v[196:199]
v_mfma_f32_16x16x32_bf16 v[200:203], v[64:67], a[4:7], v[200:203]
v_mfma_f32_16x16x32_bf16 v[204:207], v[64:67], a[8:11], v[204:207]
v_cvt_pk_bf16_f32 v95, v154, v155
v_mfma_f32_16x16x32_bf16 v[208:211], v[64:67], a[12:15], v[208:211]
v_cvt_pk_bf16_f32 v96, v156, v157
v_mfma_f32_16x16x32_bf16 v[212:215], v[64:67], a[16:19], v[212:215]
v_mfma_f32_16x16x32_bf16 v[216:219], v[64:67], a[20:23], v[216:219]
v_cvt_pk_bf16_f32 v97, v158, v159
v_mfma_f32_16x16x32_bf16 v[220:223], v[64:67], a[24:27], v[220:223]
v_cvt_pk_bf16_f32 v98, v160, v161
v_mfma_f32_16x16x32_bf16 v[196:199], v[68:71], a[28:31], v[196:199]
v_mfma_f32_16x16x32_bf16 v[200:203], v[68:71], a[32:35], v[200:203]
v_cvt_pk_bf16_f32 v99, v162, v163
v_mfma_f32_16x16x32_bf16 v[204:207], v[68:71], a[36:39], v[204:207]
v_cvt_pk_bf16_f32 v54, v164, v165
v_mfma_f32_16x16x32_bf16 v[208:211], v[68:71], a[40:43], v[208:211]
v_mfma_f32_16x16x32_bf16 v[212:215], v[68:71], a[44:47], v[212:215]
v_cvt_pk_bf16_f32 v55, v166, v167
v_mfma_f32_16x16x32_bf16 v[216:219], v[68:71], a[48:51], v[216:219]
v_mfma_f32_16x16x32_bf16 v[220:223], v[68:71], a[52:55], v[220:223]
v_mfma_f32_16x16x32_bf16 v[196:199], v[72:75], a[56:59], v[196:199]
v_mfma_f32_16x16x32_bf16 v[200:203], v[72:75], a[60:63], v[200:203]
s_add_u32 s52, s39, 20480
v_mfma_f32_16x16x32_bf16 v[204:207], v[72:75], a[64:67], v[204:207]
buffer_store_dwordx4 v[88:91], v250, s[20:23], s52 offen offset:1024 sc1
v_mfma_f32_16x16x32_bf16 v[208:211], v[72:75], a[68:71], v[208:211]
v_mfma_f32_16x16x32_bf16 v[212:215], v[72:75], a[72:75], v[212:215]
v_mfma_f32_16x16x32_bf16 v[216:219], v[72:75], a[76:79], v[216:219]
v_mfma_f32_16x16x32_bf16 v[220:223], v[72:75], a[80:83], v[220:223]
v_mfma_f32_16x16x32_bf16 v[196:199], v[76:79], a[84:87], v[196:199]
s_add_u32 s52, s39, 20480
v_mfma_f32_16x16x32_bf16 v[200:203], v[76:79], a[88:91], v[200:203]
buffer_store_dwordx4 v[92:95], v250, s[20:23], s52 offen offset:2048 sc1
v_mfma_f32_16x16x32_bf16 v[204:207], v[76:79], a[92:95], v[204:207]
v_mfma_f32_16x16x32_bf16 v[208:211], v[76:79], a[96:99], v[208:211]
v_mfma_f32_16x16x32_bf16 v[212:215], v[76:79], a[100:103], v[212:215]
v_mfma_f32_16x16x32_bf16 v[216:219], v[76:79], a[104:107], v[216:219]
v_mfma_f32_16x16x32_bf16 v[220:223], v[76:79], a[108:111], v[220:223]
s_add_u32 s52, s39, 20480
v_mfma_f32_16x16x32_bf16 v[196:199], v[80:83], a[112:115], v[196:199]
buffer_store_dwordx4 v[96:99], v250, s[20:23], s52 offen offset:3072 sc1
v_mfma_f32_16x16x32_bf16 v[200:203], v[80:83], a[116:119], v[200:203]
v_mfma_f32_16x16x32_bf16 v[204:207], v[80:83], a[120:123], v[204:207]
v_mfma_f32_16x16x32_bf16 v[208:211], v[80:83], a[124:127], v[208:211]
v_mfma_f32_16x16x32_bf16 v[212:215], v[80:83], a[128:131], v[212:215]
v_mfma_f32_16x16x32_bf16 v[216:219], v[80:83], a[132:135], v[216:219]
s_add_u32 s52, s39, 28672
v_mfma_f32_16x16x32_bf16 v[220:223], v[80:83], a[136:139], v[220:223]
buffer_store_dwordx4 v[52:55], v250, s[20:23], s52 offen offset:2048 sc1
v_mfma_f32_16x16x32_bf16 v[196:199], v[84:87], a[140:143], v[196:199]
v_mfma_f32_16x16x32_bf16 v[200:203], v[84:87], a[144:147], v[200:203]
v_mfma_f32_16x16x32_bf16 v[204:207], v[84:87], a[148:151], v[204:207]
v_mfma_f32_16x16x32_bf16 v[208:211], v[84:87], a[152:155], v[208:211]
v_mfma_f32_16x16x32_bf16 v[212:215], v[84:87], a[156:159], v[212:215]
v_mfma_f32_16x16x32_bf16 v[216:219], v[84:87], a[160:163], v[216:219]
v_mfma_f32_16x16x32_bf16 v[220:223], v[84:87], a[164:167], v[220:223]
s_load_dwordx4 s[28:31], s[0:1], 80
s_nop 4
v_cvt_pk_bf16_f32 v32, v196, v197
v_cvt_pk_bf16_f32 v33, v198, v199
v_cvt_pk_bf16_f32 v34, v200, v201
v_cvt_pk_bf16_f32 v35, v202, v203
s_add_u32 s52, s39, 24576
buffer_store_dwordx4 v[32:35], v250, s[20:23], s52 offen offset:0 sc1
v_cvt_pk_bf16_f32 v36, v204, v205
v_cvt_pk_bf16_f32 v37, v206, v207
v_cvt_pk_bf16_f32 v38, v208, v209
v_cvt_pk_bf16_f32 v39, v210, v211
s_add_u32 s52, s39, 24576
buffer_store_dwordx4 v[36:39], v250, s[20:23], s52 offen offset:1024 sc1
v_cvt_pk_bf16_f32 v40, v212, v213
v_cvt_pk_bf16_f32 v41, v214, v215
v_cvt_pk_bf16_f32 v42, v216, v217
v_cvt_pk_bf16_f32 v43, v218, v219
s_add_u32 s52, s39, 24576
buffer_store_dwordx4 v[40:43], v250, s[20:23], s52 offen offset:2048 sc1
v_cvt_pk_bf16_f32 v48, v220, v221
v_cvt_pk_bf16_f32 v49, v222, v223
s_add_u32 s52, s39, 28672
buffer_store_dwordx4 v[48:51], v250, s[20:23], s52 offen offset:3072 sc1
v_lshrrev_b32 v28, 2, v250
s_lshl_b32 s51, s24, 8
s_add_u32 s55, s101, s51
buffer_load_dword v29, v28, s[20:23], s55 offen sc1
s_cmp_eq_u32 s25, 1
s_cbranch_scc1 L1_wt2
s_mov_b32 s40, s46
s_mov_b32 s41, s47
s_mov_b32 s42, 4718592
s_mov_b32 s43, 0x20000
s_lshl_b32 s51, s26, 3
s_add_u32 s51, s51, s27
s_lshl_b32 s51, s51, 2
s_add_u32 s51, s51, s24
s_mul_i32 s51, s51, 9216
v_lshlrev_b32 v4, 3, v250
buffer_load_dword v5, v4, s[40:43], s51 offen
buffer_load_dword v6, v4, s[40:43], s51 offen offset:1024
L1_wt2:
s_lshl_b32 s32, s25, 3
s_add_u32 s32, s32, s27
s_lshl_b32 s33, s32, 4
s_lshl_b32 s34, 1, s26
s_and_b32 s54, s101, 0xffffc000
s_lshl_b32 s51, s26, 2
s_add_u32 s54, s54, s51
v_lshlrev_b32 v30, 4, v250
v_mov_b32 v0, 0
v_mov_b32 v1, 1
v_bfe_u32 v2, v250, 6, 2
v_lshrrev_b32 v3, 8, v250
v_cmp_eq_u32 vcc, v2, v3
v_and_b32 v2, 16, v250
v_mov_b32 v3, 0x3f80
v_lshlrev_b32 v2, v2, v3
v_cndmask_b32 v2, 0, v2, vcc
v_and_b32 v3, 32, v250
v_cmp_eq_u32 vcc, 0, v3
v_mov_b32 v160, 0
v_mov_b32 v161, 0
v_mov_b32 v164, 0
v_mov_b32 v165, 0
v_cndmask_b32 v162, 0, v2, vcc
v_cndmask_b32 v163, v2, v0, vcc
v_bfe_u32 v2, v250, 4, 4
v_lshrrev_b32 v3, 8, v250
v_mul_u32_u24 v2, 2304, v2
v_lshl_add_u32 v2, v3, 3, v2
s_waitcnt lgkmcnt(0)
s_mov_b32 s4, s28
s_mov_b32 s5, s29
s_mov_b32 s6, 2064384
s_mov_b32 s8, s30
s_mov_b32 s9, s31
s_mov_b32 s10, 256
s_lshl_b32 s36, s26, 2
s_add_u32 s36, s36, s24
s_mov_b32 s48, 0
L1_red:
s_lshl_b32 s37, s36, 11
s_lshl_b32 s38, s32, 21
s_add_u32 s37, s37, s38
s_mul_i32 s38, s27, 258048
s_mul_i32 s51, s25, 1152
s_add_u32 s38, s38, s51
s_lshr_b32 s51, s36, 4
s_lshl_b32 s51, s51, 5
s_add_u32 s38, s38, s51
s_and_b32 s36, s36, 15
s_lshl_b32 s36, s36, 1
s_mul_i32 s40, s36, 86
s_lshr_b32 s40, s40, 8
s_mul_i32 s41, s40, 3
s_sub_u32 s41, s36, s41
s_lshl_b32 s41, s41, 1
s_add_u32 s43, s41, 1
s_sub_u32 s51, s36, 27
s_lshl_b32 s51, s51, 1
s_add_u32 s52, s51, 1
s_cmp_lt_u32 s36, 27
s_cselect_b32 s42, s40, s52
s_cselect_b32 s40, s40, s51
s_cselect_b32 s41, s41, 6
s_cselect_b32 s43, s43, 6
s_add_u32 s40, s40, s27
s_sub_u32 s51, s40, 9
s_cmp_ge_u32 s40, 9
s_cselect_b32 s40, s51, s40
s_lshl_b32 s40, s40, 7
s_mul_i32 s41, s41, 36864
s_add_u32 s40, s40, s41
s_add_u32 s40, s40, s38
s_add_u32 s42, s42, s27
s_sub_u32 s51, s42, 9
s_cmp_ge_u32 s42, 9
s_cselect_b32 s42, s51, s42
s_lshl_b32 s42, s42, 7
s_mul_i32 s43, s43, 36864
s_add_u32 s42, s42, s43
s_add_u32 s42, s42, s38
s_add_u32 s36, s36, 1
s_mul_i32 s44, s36, 86
s_lshr_b32 s44, s44, 8
s_mul_i32 s45, s44, 3
s_sub_u32 s45, s36, s45
s_lshl_b32 s45, s45, 1
s_add_u32 s47, s45, 1
s_sub_u32 s51, s36, 27
s_lshl_b32 s51, s51, 1
s_add_u32 s52, s51, 1
s_cmp_lt_u32 s36, 27
s_cselect_b32 s46, s44, s52
s_cselect_b32 s44, s44, s51
s_cselect_b32 s45, s45, 6
s_cselect_b32 s47, s47, 6
s_add_u32 s44, s44, s27
s_sub_u32 s51, s44, 9
s_cmp_ge_u32 s44, 9
s_cselect_b32 s44, s51, s44
s_lshl_b32 s44, s44, 7
s_mul_i32 s45, s45, 36864
s_add_u32 s44, s44, s45
s_add_u32 s44, s44, s38
s_add_u32 s46, s46, s27
s_sub_u32 s51, s46, 9
s_cmp_ge_u32 s46, 9
s_cselect_b32 s46, s51, s46
s_lshl_b32 s46, s46, 7
s_mul_i32 s47, s47, 36864
s_add_u32 s46, s46, s47
s_add_u32 s46, s46, s38
s_mov_b32 s35, 0
s_mov_b32 s49, 0xffff
s_cmp_eq_u32 s48, 1
s_cbranch_scc1 L1_ld
s_waitcnt vmcnt(0)
s_barrier
s_cmp_lg_u32 s24, 0
s_cbranch_scc1 L1_n0
buffer_store_dword v1, v30, s[20:23], s54 offen sc1
s_mov_b64 exec, 15
v_mov_b32 v31, 1
buffer_atomic_add v31, v28, s[8:11], s33 offen sc0 sc1
s_mov_b64 exec, -1
L1_n0:
s_mov_b32 s53, 2048
L1_chk:
v_cmp_eq_u32 vcc, 1, v29
s_or_b32 s49, vcc_lo, s34
s_and_b32 s49, s49, 0xffff
L1_ld:
s_andn2_b32 s49, s49, s35
s_cbranch_scc0 L1_nold
s_bitcmp1_b32 s49, 0
s_cbranch_scc0 L1_s0
s_add_u32 s51, s37, 0
buffer_load_dwordx4 v[32:35], v250, s[20:23], s51 offen offset:0 sc1
buffer_load_dwordx4 v[36:39], v250, s[20:23], s51 offen offset:1024 sc1
L1_s0:
s_bitcmp1_b32 s49, 1
s_cbranch_scc0 L1_s1
s_add_u32 s51, s37, 131072
buffer_load_dwordx4 v[40:43], v250, s[20:23], s51 offen offset:0 sc1
buffer_load_dwordx4 v[44:47], v250, s[20:23], s51 offen offset:1024 sc1
L1_s1:
s_bitcmp1_b32 s49, 2
s_cbranch_scc0 L1_s2
s_add_u32 s51, s37, 262144
buffer_load_dwordx4 v[48:51], v250, s[20:23], s51 offen offset:0 sc1
buffer_load_dwordx4 v[52:55], v250, s[20:23], s51 offen offset:1024 sc1
L1_s2:
s_bitcmp1_b32 s49, 3
s_cbranch_scc0 L1_s3
s_add_u32 s51, s37, 393216
buffer_load_dwordx4 v[56:59], v250, s[20:23], s51 offen offset:0 sc1
buffer_load_dwordx4 v[60:63], v250, s[20:23], s51 offen offset:1024 sc1
L1_s3:
s_bitcmp1_b32 s49, 4
s_cbranch_scc0 L1_s4
s_add_u32 s51, s37, 524288
buffer_load_dwordx4 v[64:67], v250, s[20:23], s51 offen offset:0 sc1
buffer_load_dwordx4 v[68:71], v250, s[20:23], s51 offen offset:1024 sc1
L1_s4:
s_bitcmp1_b32 s49, 5
s_cbranch_scc0 L1_s5
s_add_u32 s51, s37, 655360
buffer_load_dwordx4 v[72:75], v250, s[20:23], s51 offen offset:0 sc1
buffer_load_dwordx4 v[76:79], v250, s[20:23], s51 offen offset:1024 sc1
L1_s5:
s_bitcmp1_b32 s49, 6
s_cbranch_scc0 L1_s6
s_add_u32 s51, s37, 786432
buffer_load_dwordx4 v[80:83], v250, s[20:23], s51 offen offset:0 sc1
buffer_load_dwordx4 v[84:87], v250, s[20:23], s51 offen offset:1024 sc1
L1_s6:
s_bitcmp1_b32 s49, 7
s_cbranch_scc0 L1_s7
s_add_u32 s51, s37, 917504
buffer_load_dwordx4 v[88:91], v250, s[20:23], s51 offen offset:0 sc1
buffer_load_dwordx4 v[92:95], v250, s[20:23], s51 offen offset:1024 sc1
L1_s7:
s_bitcmp1_b32 s49, 8
s_cbranch_scc0 L1_s8
s_add_u32 s51, s37, 1048576
buffer_load_dwordx4 v[96:99], v250, s[20:23], s51 offen offset:0 sc1
buffer_load_dwordx4 v[100:103], v250, s[20:23], s51 offen offset:1024 sc1
L1_s8:
s_bitcmp1_b32 s49, 9
s_cbranch_scc0 L1_s9
s_add_u32 s51, s37, 1179648
buffer_load_dwordx4 v[104:107], v250, s[20:23], s51 offen offset:0 sc1
buffer_load_dwordx4 v[108:111], v250, s[20:23], s51 offen offset:1024 sc1
L1_s9:
s_bitcmp1_b32 s49, 10
s_cbranch_scc0 L1_s10
s_add_u32 s51, s37, 1310720
buffer_load_dwordx4 v[112:115], v250, s[20:23], s51 offen offset:0 sc1
buffer_load_dwordx4 v[116:119], v250, s[20:23], s51 offen offset:1024 sc1
L1_s10:
s_bitcmp1_b32 s49, 11
s_cbranch_scc0 L1_s11
s_add_u32 s51, s37, 1441792
buffer_load_dwordx4 v[120:123], v250, s[20:23], s51 offen offset:0 sc1
buffer_load_dwordx4 v[124:127], v250, s[20:23], s51 offen offset:1024 sc1
L1_s11:
s_bitcmp1_b32 s49, 12
s_cbranch_scc0 L1_s12
s_add_u32 s51, s37, 1572864
buffer_load_dwordx4 v[128:131], v250, s[20:23], s51 offen offset:0 sc1
buffer_load_dwordx4 v[132:135], v250, s[20:23], s51 offen offset:1024 sc1
L1_s12:
s_bitcmp1_b32 s49, 13
s_cbranch_scc0 L1_s13
s_add_u32 s51, s37, 1703936
buffer_load_dwordx4 v[136:139], v250, s[20:23], s51 offen offset:0 sc1
buffer_load_dwordx4 v[140:143], v250, s[20:23], s51 offen offset:1024 sc1
L1_s13:
s_bitcmp1_b32 s49, 14
s_cbranch_scc0 L1_s14
s_add_u32 s51, s37, 1835008
buffer_load_dwordx4 v[144:147], v250, s[20:23], s51 offen offset:0 sc1
buffer_load_dwordx4 v[148:151], v250, s[20:23], s51 offen offset:1024 sc1
L1_s14:
s_bitcmp1_b32 s49, 15
s_cbranch_scc0 L1_s15
s_add_u32 s51, s37, 1966080
buffer_load_dwordx4 v[152:155], v250, s[20:23], s51 offen offset:0 sc1
buffer_load_dwordx4 v[156:159], v250, s[20:23], s51 offen offset:1024 sc1
L1_s15:
s_or_b32 s35, s35, s49
s_cmp_eq_u32 s35, 0xffff
s_cbranch_scc1 L1_sum
L1_nold:
s_sub_u32 s53, s53, 1
s_cbranch_scc1 L1_quit
s_sleep 1
buffer_load_dword v29, v28, s[20:23], s55 offen sc1
s_waitcnt vmcnt(0)
s_branch L1_chk
L1_quit:
s_mov_b64 exec, 1
s_lshl_b32 s51, s34, 8
v_mov_b32 v29, s51
s_lshl_b32 s51, s24, 2
s_add_u32 s51, s51, s33
buffer_atomic_or v29, v0, s[8:11], s51 offen sc0 sc1
s_mov_b64 exec, -1
s_waitcnt vmcnt(0)
v_readfirstlane_b32 s51, v29
s_mov_b32 s49, 0xffff
s_bitcmp1_b32 s51, 4
s_cbranch_scc1 L1_ld
s_branch L1_nx
L1_sum:
s_cmp_eq_u32 s49, 0xffff
s_cselect_b32 s49, 0, s49
s_bitcmp1_b32 s49, 0
s_cbranch_scc0 L1_w0
s_waitcnt vmcnt(0)
L1_w0:
s_waitcnt vmcnt(30)
v_mfma_f32_16x16x32_bf16 v[4:7], v[162:165], v[32:35], 0
v_mfma_f32_16x16x32_bf16 v[8:11], v[160:163], v[32:35], 0
v_mfma_f32_16x16x32_bf16 v[12:15], v[162:165], v[36:39], 0
v_mfma_f32_16x16x32_bf16 v[16:19], v[160:163], v[36:39], 0
s_bitcmp1_b32 s49, 1
s_cbranch_scc0 L1_w1
s_waitcnt vmcnt(0)
L1_w1:
s_waitcnt vmcnt(28)
v_mfma_f32_16x16x32_bf16 v[4:7], v[162:165], v[40:43], v[4:7]
v_mfma_f32_16x16x32_bf16 v[8:11], v[160:163], v[40:43], v[8:11]
v_mfma_f32_16x16x32_bf16 v[12:15], v[162:165], v[44:47], v[12:15]
v_mfma_f32_16x16x32_bf16 v[16:19], v[160:163], v[44:47], v[16:19]
s_bitcmp1_b32 s49, 2
s_cbranch_scc0 L1_w2
s_waitcnt vmcnt(0)
L1_w2:
s_waitcnt vmcnt(26)
v_mfma_f32_16x16x32_bf16 v[4:7], v[162:165], v[48:51], v[4:7]
v_mfma_f32_16x16x32_bf16 v[8:11], v[160:163], v[48:51], v[8:11]
v_mfma_f32_16x16x32_bf16 v[12:15], v[162:165], v[52:55], v[12:15]
v_mfma_f32_16x16x32_bf16 v[16:19], v[160:163], v[52:55], v[16:19]
s_bitcmp1_b32 s49, 3
s_cbranch_scc0 L1_w3
s_waitcnt vmcnt(0)
L1_w3:
s_waitcnt vmcnt(24)
v_mfma_f32_16x16x32_bf16 v[4:7], v[162:165], v[56:59], v[4:7]
v_mfma_f32_16x16x32_bf16 v[8:11], v[160:163], v[56:59], v[8:11]
v_mfma_f32_16x16x32_bf16 v[12:15], v[162:165], v[60:63], v[12:15]
v_mfma_f32_16x16x32_bf16 v[16:19], v[160:163], v[60:63], v[16:19]
s_bitcmp1_b32 s49, 4
s_cbranch_scc0 L1_w4
s_waitcnt vmcnt(0)
L1_w4:
s_waitcnt vmcnt(22)
v_mfma_f32_16x16x32_bf16 v[4:7], v[162:165], v[64:67], v[4:7]
v_mfma_f32_16x16x32_bf16 v[8:11], v[160:163], v[64:67], v[8:11]
v_mfma_f32_16x16x32_bf16 v[12:15], v[162:165], v[68:71], v[12:15]
v_mfma_f32_16x16x32_bf16 v[16:19], v[160:163], v[68:71], v[16:19]
s_bitcmp1_b32 s49, 5
s_cbranch_scc0 L1_w5
s_waitcnt vmcnt(0)
L1_w5:
s_waitcnt vmcnt(20)
v_mfma_f32_16x16x32_bf16 v[4:7], v[162:165], v[72:75], v[4:7]
v_mfma_f32_16x16x32_bf16 v[8:11], v[160:163], v[72:75], v[8:11]
v_mfma_f32_16x16x32_bf16 v[12:15], v[162:165], v[76:79], v[12:15]
v_mfma_f32_16x16x32_bf16 v[16:19], v[160:163], v[76:79], v[16:19]
s_bitcmp1_b32 s49, 6
s_cbranch_scc0 L1_w6
s_waitcnt vmcnt(0)
L1_w6:
s_waitcnt vmcnt(18)
v_mfma_f32_16x16x32_bf16 v[4:7], v[162:165], v[80:83], v[4:7]
v_mfma_f32_16x16x32_bf16 v[8:11], v[160:163], v[80:83], v[8:11]
v_mfma_f32_16x16x32_bf16 v[12:15], v[162:165], v[84:87], v[12:15]
v_mfma_f32_16x16x32_bf16 v[16:19], v[160:163], v[84:87], v[16:19]
s_bitcmp1_b32 s49, 7
s_cbranch_scc0 L1_w7
s_waitcnt vmcnt(0)
L1_w7:
s_waitcnt vmcnt(16)
v_mfma_f32_16x16x32_bf16 v[4:7], v[162:165], v[88:91], v[4:7]
v_mfma_f32_16x16x32_bf16 v[8:11], v[160:163], v[88:91], v[8:11]
v_mfma_f32_16x16x32_bf16 v[12:15], v[162:165], v[92:95], v[12:15]
v_mfma_f32_16x16x32_bf16 v[16:19], v[160:163], v[92:95], v[16:19]
s_bitcmp1_b32 s49, 8
s_cbranch_scc0 L1_w8
s_waitcnt vmcnt(0)
L1_w8:
s_waitcnt vmcnt(14)
v_mfma_f32_16x16x32_bf16 v[4:7], v[162:165], v[96:99], v[4:7]
v_mfma_f32_16x16x32_bf16 v[8:11], v[160:163], v[96:99], v[8:11]
v_mfma_f32_16x16x32_bf16 v[12:15], v[162:165], v[100:103], v[12:15]
v_mfma_f32_16x16x32_bf16 v[16:19], v[160:163], v[100:103], v[16:19]
s_bitcmp1_b32 s49, 9
s_cbranch_scc0 L1_w9
s_waitcnt vmcnt(0)
L1_w9:
s_waitcnt vmcnt(12)
v_mfma_f32_16x16x32_bf16 v[4:7], v[162:165], v[104:107], v[4:7]
v_mfma_f32_16x16x32_bf16 v[8:11], v[160:163], v[104:107], v[8:11]
v_mfma_f32_16x16x32_bf16 v[12:15], v[162:165], v[108:111], v[12:15]
v_mfma_f32_16x16x32_bf16 v[16:19], v[160:163], v[108:111], v[16:19]
s_bitcmp1_b32 s49, 10
s_cbranch_scc0 L1_w10
s_waitcnt vmcnt(0)
L1_w10:
s_waitcnt vmcnt(10)
v_mfma_f32_16x16x32_bf16 v[4:7], v[162:165], v[112:115], v[4:7]
v_mfma_f32_16x16x32_bf16 v[8:11], v[160:163], v[112:115], v[8:11]
v_mfma_f32_16x16x32_bf16 v[12:15], v[162:165], v[116:119], v[12:15]
v_mfma_f32_16x16x32_bf16 v[16:19], v[160:163], v[116:119], v[16:19]
s_bitcmp1_b32 s49, 11
s_cbranch_scc0 L1_w11
s_waitcnt vmcnt(0)
L1_w11:
s_waitcnt vmcnt(8)
v_mfma_f32_16x16x32_bf16 v[4:7], v[162:165], v[120:123], v[4:7]
v_mfma_f32_16x16x32_bf16 v[8:11], v[160:163], v[120:123], v[8:11]
v_mfma_f32_16x16x32_bf16 v[12:15], v[162:165], v[124:127], v[12:15]
v_mfma_f32_16x16x32_bf16 v[16:19], v[160:163], v[124:127], v[16:19]
s_bitcmp1_b32 s49, 12
s_cbranch_scc0 L1_w12
s_waitcnt vmcnt(0)
L1_w12:
s_waitcnt vmcnt(6)
v_mfma_f32_16x16x32_bf16 v[4:7], v[162:165], v[128:131], v[4:7]
v_mfma_f32_16x16x32_bf16 v[8:11], v[160:163], v[128:131], v[8:11]
v_mfma_f32_16x16x32_bf16 v[12:15], v[162:165], v[132:135], v[12:15]
v_mfma_f32_16x16x32_bf16 v[16:19], v[160:163], v[132:135], v[16:19]
s_bitcmp1_b32 s49, 13
s_cbranch_scc0 L1_w13
s_waitcnt vmcnt(0)
L1_w13:
s_waitcnt vmcnt(4)
v_mfma_f32_16x16x32_bf16 v[4:7], v[162:165], v[136:139], v[4:7]
v_mfma_f32_16x16x32_bf16 v[8:11], v[160:163], v[136:139], v[8:11]
v_mfma_f32_16x16x32_bf16 v[12:15], v[162:165], v[140:143], v[12:15]
v_mfma_f32_16x16x32_bf16 v[16:19], v[160:163], v[140:143], v[16:19]
s_bitcmp1_b32 s49, 14
s_cbranch_scc0 L1_w14
s_waitcnt vmcnt(0)
L1_w14:
s_waitcnt vmcnt(2)
v_mfma_f32_16x16x32_bf16 v[4:7], v[162:165], v[144:147], v[4:7]
v_mfma_f32_16x16x32_bf16 v[8:11], v[160:163], v[144:147], v[8:11]
v_mfma_f32_16x16x32_bf16 v[12:15], v[162:165], v[148:151], v[12:15]
v_mfma_f32_16x16x32_bf16 v[16:19], v[160:163], v[148:151], v[16:19]
s_bitcmp1_b32 s49, 15
s_cbranch_scc0 L1_w15
s_waitcnt vmcnt(0)
L1_w15:
s_waitcnt vmcnt(0)
v_mfma_f32_16x16x32_bf16 v[4:7], v[162:165], v[152:155], v[4:7]
v_mfma_f32_16x16x32_bf16 v[8:11], v[160:163], v[152:155], v[8:11]
v_mfma_f32_16x16x32_bf16 v[12:15], v[162:165], v[156:159], v[12:15]
v_mfma_f32_16x16x32_bf16 v[16:19], v[160:163], v[156:159], v[16:19]
s_nop 7
v_cvt_pk_bf16_f32 v20, v4, v5
v_cvt_pk_bf16_f32 v21, v6, v7
v_cvt_pk_bf16_f32 v22, v8, v9
v_cvt_pk_bf16_f32 v23, v10, v11
v_cvt_pk_bf16_f32 v24, v12, v13
v_cvt_pk_bf16_f32 v25, v14, v15
v_cvt_pk_bf16_f32 v26, v16, v17
v_cvt_pk_bf16_f32 v27, v18, v19
buffer_store_dwordx2 v[20:21], v2, s[4:7], s40 offen
buffer_store_dwordx2 v[22:23], v2, s[4:7], s42 offen
buffer_store_dwordx2 v[24:25], v2, s[4:7], s44 offen
s_cmp_eq_u32 s36, 31
s_cbranch_scc1 L1_nx
buffer_store_dwordx2 v[26:27], v2, s[4:7], s46 offen
L1_nx:
s_cmp_lg_u32 s24, 0
s_cbranch_scc1 L1_done
s_cmp_eq_u32 s48, 1
s_cbranch_scc1 L1_more
s_mov_b32 s48, 1
v_readlane_b32 s51, v31, 0
s_and_b32 s52, s51, 31
s_bfe_u32 s51, s51, 0x100008
s_cmp_eq_u32 s52, 15
s_cselect_b32 s51, s51, 0
s_mov_b32 s58, s51
v_readlane_b32 s51, v31, 1
s_and_b32 s52, s51, 31
s_bfe_u32 s51, s51, 0x100008
s_cmp_eq_u32 s52, 15
s_cselect_b32 s51, s51, 0
s_lshl_b32 s51, s51, 16
s_or_b32 s58, s58, s51
v_readlane_b32 s51, v31, 2
s_and_b32 s52, s51, 31
s_bfe_u32 s51, s51, 0x100008
s_cmp_eq_u32 s52, 15
s_cselect_b32 s51, s51, 0
s_mov_b32 s59, s51
v_readlane_b32 s51, v31, 3
s_and_b32 s52, s51, 31
s_bfe_u32 s51, s51, 0x100008
s_cmp_eq_u32 s52, 15
s_cselect_b32 s51, s51, 0
s_lshl_b32 s51, s51, 16
s_or_b32 s59, s59, s51
L1_more:
s_cmp_eq_u64 s[58:59], 0
s_cbranch_scc1 L1_done
s_ff1_i32_b64 s51, s[58:59]
s_bitset0_b64 s[58:59], s51
s_and_b32 s36, s51, 15
s_lshl_b32 s36, s36, 2
s_lshr_b32 s51, s51, 4
s_add_u32 s36, s36, s51
s_branch L1_red
L1_done:
L1_end:
s_endpgm
L1_slow:
s_mov_b32 s57, 1
s_waitcnt lgkmcnt(0)
s_barrier
v_mov_b32 v200, 0xff800000
v_mov_b32 v204, 0xff800000
v_mov_b32 v208, 0xff800000
v_mov_b32 v212, 0xff800000
v_mov_b32 v216, 0xff800000
v_mov_b32 v220, 0xff800000
v_mov_b32 v224, 0xff800000
s_mov_b32 s56, 0
L1_mx:
s_add_u32 m0, s50, 0
s_add_u32 s51, s56, 0
s_xor_b32 s51, s51, s33
buffer_load_dwordx4 v244, s[12:15], s51 offen offset:0 nt lds
buffer_load_dwordx4 v245, s[12:15], s51 offen offset:1024 nt lds
buffer_load_dwordx4 v246, s[12:15], s51 offen offset:2048 nt lds
buffer_load_dwordx4 v247, s[12:15], s51 offen offset:3072 nt lds
s_add_u32 m0, s50, 4096
s_add_u32 s51, s56, 4096
s_xor_b32 s51, s51, s33
buffer_load_dwordx4 v244, s[12:15], s51 offen offset:0 nt lds
buffer_load_dwordx4 v245, s[12:15], s51 offen offset:1024 nt lds
buffer_load_dwordx4 v246, s[12:15], s51 offen offset:2048 nt lds
buffer_load_dwordx4 v247, s[12:15], s51 offen offset:3072 nt lds
s_waitcnt vmcnt(0)
ds_read_b128 v[112:115], v232 offset:0
ds_read_b128 v[128:131], v232 offset:4096
ds_read_b128 v[116:119], v233 offset:0
ds_read_b128 v[132:135], v233 offset:4096
ds_read_b128 v[120:123], v234 offset:0
ds_read_b128 v[136:139], v234 offset:4096
ds_read_b128 v[124:127], v235 offset:0
ds_read_b128 v[140:143], v235 offset:4096
s_waitcnt lgkmcnt(0)
v_mfma_f32_16x16x32_bf16 v[176:179], v[112:115], a[0:3], 0
v_mfma_f32_16x16x32_bf16 v[180:183], v[128:131], a[0:3], 0
v_mfma_f32_16x16x32_bf16 v[176:179], v[116:119], a[4:7], v[176:179]
v_mfma_f32_16x16x32_bf16 v[180:183], v[132:135], a[4:7], v[180:183]
v_mfma_f32_16x16x32_bf16 v[176:179], v[120:123], a[8:11], v[176:179]
v_mfma_f32_16x16x32_bf16 v[180:183], v[136:139], a[8:11], v[180:183]
v_mfma_f32_16x16x32_bf16 v[176:179], v[124:127], a[12:15], v[176:179]
v_mfma_f32_16x16x32_bf16 v[180:183], v[140:143], a[12:15], v[180:183]
s_nop 7
v_max3_f32 v200, v176, v177, v200
v_max3_f32 v200, v178, v179, v200
v_max3_f32 v200, v180, v181, v200
v_max3_f32 v200, v182, v183, v200
v_mfma_f32_16x16x32_bf16 v[176:179], v[112:115], a[16:19], 0
v_mfma_f32_16x16x32_bf16 v[180:183], v[128:131], a[16:19], 0
v_mfma_f32_16x16x32_bf16 v[176:179], v[116:119], a[20:23], v[176:179]
v_mfma_f32_16x16x32_bf16 v[180:183], v[132:135], a[20:23], v[180:183]
v_mfma_f32_16x16x32_bf16 v[176:179], v[120:123], a[24:27], v[176:179]
v_mfma_f32_16x16x32_bf16 v[180:183], v[136:139], a[24:27], v[180:183]
v_mfma_f32_16x16x32_bf16 v[176:179], v[124:127], a[28:31], v[176:179]
v_mfma_f32_16x16x32_bf16 v[180:183], v[140:143], a[28:31], v[180:183]
s_nop 7
v_max3_f32 v204, v176, v177, v204
v_max3_f32 v204, v178, v179, v204
v_max3_f32 v204, v180, v181, v204
v_max3_f32 v204, v182, v183, v204
v_mfma_f32_16x16x32_bf16 v[176:179], v[112:115], a[32:35], 0
v_mfma_f32_16x16x32_bf16 v[180:183], v[128:131], a[32:35], 0
v_mfma_f32_16x16x32_bf16 v[176:179], v[116:119], a[36:39], v[176:179]
v_mfma_f32_16x16x32_bf16 v[180:183], v[132:135], a[36:39], v[180:183]
v_mfma_f32_16x16x32_bf16 v[176:179], v[120:123], a[40:43], v[176:179]
v_mfma_f32_16x16x32_bf16 v[180:183], v[136:139], a[40:43], v[180:183]
v_mfma_f32_16x16x32_bf16 v[176:179], v[124:127], a[44:47], v[176:179]
v_mfma_f32_16x16x32_bf16 v[180:183], v[140:143], a[44:47], v[180:183]
s_nop 7
v_max3_f32 v208, v176, v177, v208
v_max3_f32 v208, v178, v179, v208
v_max3_f32 v208, v180, v181, v208
v_max3_f32 v208, v182, v183, v208
v_mfma_f32_16x16x32_bf16 v[176:179], v[112:115], a[48:51], 0
v_mfma_f32_16x16x32_bf16 v[180:183], v[128:131], a[48:51], 0
v_mfma_f32_16x16x32_bf16 v[176:179], v[116:119], a[52:55], v[176:179]
v_mfma_f32_16x16x32_bf16 v[180:183], v[132:135], a[52:55], v[180:183]
v_mfma_f32_16x16x32_bf16 v[176:179], v[120:123], a[56:59], v[176:179]
v_mfma_f32_16x16x32_bf16 v[180:183], v[136:139], a[56:59], v[180:183]
v_mfma_f32_16x16x32_bf16 v[176:179], v[124:127], a[60:63], v[176:179]
v_mfma_f32_16x16x32_bf16 v[180:183], v[140:143], a[60:63], v[180:183]
s_nop 7
v_max3_f32 v212, v176, v177, v212
v_max3_f32 v212, v178, v179, v212
v_max3_f32 v212, v180, v181, v212
v_max3_f32 v212, v182, v183, v212
v_mfma_f32_16x16x32_bf16 v[176:179], v[112:115], a[64:67], 0
v_mfma_f32_16x16x32_bf16 v[180:183], v[128:131], a[64:67], 0
v_mfma_f32_16x16x32_bf16 v[176:179], v[116:119], a[68:71], v[176:179]
v_mfma_f32_16x16x32_bf16 v[180:183], v[132:135], a[68:71], v[180:183]
v_mfma_f32_16x16x32_bf16 v[176:179], v[120:123], a[72:75], v[176:179]
v_mfma_f32_16x16x32_bf16 v[180:183], v[136:139], a[72:75], v[180:183]
v_mfma_f32_16x16x32_bf16 v[176:179], v[124:127], a[76:79], v[176:179]
v_mfma_f32_16x16x32_bf16 v[180:183], v[140:143], a[76:79], v[180:183]
s_nop 7
v_max3_f32 v216, v176, v177, v216
v_max3_f32 v216, v178, v179, v216
v_max3_f32 v216, v180, v181, v216
v_max3_f32 v216, v182, v183, v216
v_mfma_f32_16x16x32_bf16 v[176:179], v[112:115], a[80:83], 0
v_mfma_f32_16x16x32_bf16 v[180:183], v[128:131], a[80:83], 0
v_mfma_f32_16x16x32_bf16 v[176:179], v[116:119], a[84:87], v[176:179]
v_mfma_f32_16x16x32_bf16 v[180:183], v[132:135], a[84:87], v[180:183]
v_mfma_f32_16x16x32_bf16 v[176:179], v[120:123], a[88:91], v[176:179]
v_mfma_f32_16x16x32_bf16 v[180:183], v[136:139], a[88:91], v[180:183]
v_mfma_f32_16x16x32_bf16 v[176:179], v[124:127], a[92:95], v[176:179]
v_mfma_f32_16x16x32_bf16 v[180:183], v[140:143], a[92:95], v[180:183]
s_nop 7
v_max3_f32 v220, v176, v177, v220
v_max3_f32 v220, v178, v179, v220
v_max3_f32 v220, v180, v181, v220
v_max3_f32 v220, v182, v183, v220
v_mfma_f32_16x16x32_bf16 v[176:179], v[112:115], a[96:99], 0
v_mfma_f32_16x16x32_bf16 v[180:183], v[128:131], a[96:99], 0
v_mfma_f32_16x16x32_bf16 v[176:179], v[116:119], a[100:103], v[176:179]
v_mfma_f32_16x16x32_bf16 v[180:183], v[132:135], a[100:103], v[180:183]
v_mfma_f32_16x16x32_bf16 v[176:179], v[120:123], a[104:107], v[176:179]
v_mfma_f32_16x16x32_bf16 v[180:183], v[136:139], a[104:107], v[180:183]
v_mfma_f32_16x16x32_bf16 v[176:179], v[124:127], a[108:111], v[176:179]
v_mfma_f32_16x16x32_bf16 v[180:183], v[140:143], a[108:111], v[180:183]
s_nop 7
v_max3_f32 v224, v176, v177, v224
v_max3_f32 v224, v178, v179, v224
v_max3_f32 v224, v180, v181, v224
v_max3_f32 v224, v182, v183, v224
s_add_u32 s56, s56, 8192
s_cmp_lt_u32 s56, 131072
s_cbranch_scc1 L1_mx
v_lshrrev_b32 v176, 2, v250
v_add_u32 v177, s50, v176
ds_write_b32 v177, v200 offset:16384
ds_write_b32 v177, v204 offset:16640
ds_write_b32 v177, v208 offset:16896
ds_write_b32 v177, v212 offset:17152
ds_write_b32 v177, v216 offset:17408
ds_write_b32 v177, v220 offset:17664
ds_write_b32 v177, v224 offset:17920
s_and_b32 s51, s50, 65536
v_and_b32 v176, 63, v176
v_add_u32 v176, s51, v176
s_waitcnt lgkmcnt(0)
s_barrier
ds_read_b32 v112, v176 offset:16384
ds_read_b32 v113, v176 offset:16448
ds_read_b32 v114, v176 offset:16512
ds_read_b32 v115, v176 offset:16576
ds_read_b32 v116, v176 offset:49152
ds_read_b32 v117, v176 offset:49216
ds_read_b32 v118, v176 offset:49280
ds_read_b32 v119, v176 offset:49344
s_waitcnt lgkmcnt(0)
v_max3_f32 v200, v112, v113, v200
v_max3_f32 v200, v114, v115, v200
v_max3_f32 v200, v116, v117, v200
v_max3_f32 v200, v118, v119, v200
v_sub_f32 v203, 0, v200
v_sub_f32 v202, 0, v200
v_sub_f32 v201, 0, v200
v_sub_f32 v200, 0, v200
ds_read_b32 v112, v176 offset:16640
ds_read_b32 v113, v176 offset:16704
ds_read_b32 v114, v176 offset:16768
ds_read_b32 v115, v176 offset:16832
ds_read_b32 v116, v176 offset:49408
ds_read_b32 v117, v176 offset:49472
ds_read_b32 v118, v176 offset:49536
ds_read_b32 v119, v176 offset:49600
s_waitcnt lgkmcnt(0)
v_max3_f32 v204, v112, v113, v204
v_max3_f32 v204, v114, v115, v204
v_max3_f32 v204, v116, v117, v204
v_max3_f32 v204, v118, v119, v204
v_sub_f32 v207, 0, v204
v_sub_f32 v206, 0, v204
v_sub_f32 v205, 0, v204
v_sub_f32 v204, 0, v204
ds_read_b32 v112, v176 offset:16896
ds_read_b32 v113, v176 offset:16960
ds_read_b32 v114, v176 offset:17024
ds_read_b32 v115, v176 offset:17088
ds_read_b32 v116, v176 offset:49664
ds_read_b32 v117, v176 offset:49728
ds_read_b32 v118, v176 offset:49792
ds_read_b32 v119, v176 offset:49856
s_waitcnt lgkmcnt(0)
v_max3_f32 v208, v112, v113, v208
v_max3_f32 v208, v114, v115, v208
v_max3_f32 v208, v116, v117, v208
v_max3_f32 v208, v118, v119, v208
v_sub_f32 v211, 0, v208
v_sub_f32 v210, 0, v208
v_sub_f32 v209, 0, v208
v_sub_f32 v208, 0, v208
ds_read_b32 v112, v176 offset:17152
ds_read_b32 v113, v176 offset:17216
ds_read_b32 v114, v176 offset:17280
ds_read_b32 v115, v176 offset:17344
ds_read_b32 v116, v176 offset:49920
ds_read_b32 v117, v176 offset:49984
ds_read_b32 v118, v176 offset:50048
ds_read_b32 v119, v176 offset:50112
s_waitcnt lgkmcnt(0)
v_max3_f32 v212, v112, v113, v212
v_max3_f32 v212, v114, v115, v212
v_max3_f32 v212, v116, v117, v212
v_max3_f32 v212, v118, v119, v212
v_sub_f32 v215, 0, v212
v_sub_f32 v214, 0, v212
v_sub_f32 v213, 0, v212
v_sub_f32 v212, 0, v212
ds_read_b32 v112, v176 offset:17408
ds_read_b32 v113, v176 offset:17472
ds_read_b32 v114, v176 offset:17536
ds_read_b32 v115, v176 offset:17600
ds_read_b32 v116, v176 offset:50176
ds_read_b32 v117, v176 offset:50240
ds_read_b32 v118, v176 offset:50304
ds_read_b32 v119, v176 offset:50368
s_waitcnt lgkmcnt(0)
v_max3_f32 v216, v112, v113, v216
v_max3_f32 v216, v114, v115, v216
v_max3_f32 v216, v116, v117, v216
v_max3_f32 v216, v118, v119, v216
v_sub_f32 v219, 0, v216
v_sub_f32 v218, 0, v216
v_sub_f32 v217, 0, v216
v_sub_f32 v216, 0, v216
ds_read_b32 v112, v176 offset:17664
ds_read_b32 v113, v176 offset:17728
ds_read_b32 v114, v176 offset:17792
ds_read_b32 v115, v176 offset:17856
ds_read_b32 v116, v176 offset:50432
ds_read_b32 v117, v176 offset:50496
ds_read_b32 v118, v176 offset:50560
ds_read_b32 v119, v176 offset:50624
s_waitcnt lgkmcnt(0)
v_max3_f32 v220, v112, v113, v220
v_max3_f32 v220, v114, v115, v220
v_max3_f32 v220, v116, v117, v220
v_max3_f32 v220, v118, v119, v220
v_sub_f32 v223, 0, v220
v_sub_f32 v222, 0, v220
v_sub_f32 v221, 0, v220
v_sub_f32 v220, 0, v220
ds_read_b32 v112, v176 offset:17920
ds_read_b32 v113, v176 offset:17984
ds_read_b32 v114, v176 offset:18048
ds_read_b32 v115, v176 offset:18112
ds_read_b32 v116, v176 offset:50688
ds_read_b32 v117, v176 offset:50752
ds_read_b32 v118, v176 offset:50816
ds_read_b32 v119, v176 offset:50880
s_waitcnt lgkmcnt(0)
v_max3_f32 v224, v112, v113, v224
v_max3_f32 v224, v114, v115, v224
v_max3_f32 v224, v116, v117, v224
v_max3_f32 v224, v118, v119, v224
v_sub_f32 v227, 0, v224
v_sub_f32 v226, 0, v224
v_sub_f32 v225, 0, v224
v_sub_f32 v224, 0, v224
s_barrier
s_mov_b32 s56, 0
v_mov_b32 v192, 0
v_mov_b32 v193, 0
v_mov_b32 v194, 0
v_mov_b32 v195, 0
v_mov_b32 v196, 0
v_mov_b32 v197, 0
v_mov_b32 v198, 0
v_mov_b32 v199, 0
s_add_u32 m0, s50, 0
s_add_u32 s51, s56, 0
s_xor_b32 s51, s51, s33
buffer_load_dwordx4 v244, s[12:15], s51 offen offset:0 nt lds
buffer_load_dwordx4 v245, s[12:15], s51 offen offset:1024 nt lds
buffer_load_dwordx4 v246, s[12:15], s51 offen offset:2048 nt lds
buffer_load_dwordx4 v247, s[12:15], s51 offen offset:3072 nt lds
s_add_u32 m0, s50, 4096
s_add_u32 s51, s56, 4096
s_xor_b32 s51, s51, s33
buffer_load_dwordx4 v244, s[12:15], s51 offen offset:0 nt lds
buffer_load_dwordx4 v245, s[12:15], s51 offen offset:1024 nt lds
buffer_load_dwordx4 v246, s[12:15], s51 offen offset:2048 nt lds
buffer_load_dwordx4 v247, s[12:15], s51 offen offset:3072 nt lds
s_add_u32 m0, s50, 8192
s_add_u32 s51, s56, 0
s_xor_b32 s51, s51, s33
buffer_load_dwordx4 v248, s[16:19], s51 offen offset:0 nt lds
buffer_load_dwordx4 v249, s[16:19], s51 offen offset:1024 nt lds
buffer_load_dwordx4 v248, s[16:19], s51 offen offset:2048 nt lds
buffer_load_dwordx4 v249, s[16:19], s51 offen offset:3072 nt lds
s_add_u32 m0, s50, 12288
s_add_u32 s51, s56, 4096
s_xor_b32 s51, s51, s33
buffer_load_dwordx4 v248, s[16:19], s51 offen offset:0 nt lds
buffer_load_dwordx4 v249, s[16:19], s51 offen offset:1024 nt lds
buffer_load_dwordx4 v248, s[16:19], s51 offen offset:2048 nt lds
buffer_load_dwordx4 v249, s[16:19], s51 offen offset:3072 nt lds
s_add_u32 m0, s50, 16384
s_add_u32 s51, s56, 8192
s_xor_b32 s51, s51, s33
buffer_load_dwordx4 v244, s[12:15], s51 offen offset:0 nt lds
buffer_load_dwordx4 v245, s[12:15], s51 offen offset:1024 nt lds
buffer_load_dwordx4 v246, s[12:15], s51 offen offset:2048 nt lds
buffer_load_dwordx4 v247, s[12:15], s51 offen offset:3072 nt lds
s_add_u32 m0, s50, 20480
s_add_u32 s51, s56, 12288
s_xor_b32 s51, s51, s33
buffer_load_dwordx4 v244, s[12:15], s51 offen offset:0 nt lds
buffer_load_dwordx4 v245, s[12:15], s51 offen offset:1024 nt lds
buffer_load_dwordx4 v246, s[12:15], s51 offen offset:2048 nt lds
buffer_load_dwordx4 v247, s[12:15], s51 offen offset:3072 nt lds
v_mfma_f32_32x32x16_bf16 v[0:15], v[192:195], v[192:195], 0
v_mfma_f32_32x32x16_bf16 v[16:31], v[192:195], v[192:195], 0
v_mfma_f32_32x32x16_bf16 v[32:47], v[192:195], v[192:195], 0
v_mfma_f32_32x32x16_bf16 v[48:63], v[192:195], v[192:195], 0
v_mfma_f32_32x32x16_bf16 v[64:79], v[192:195], v[192:195], 0
v_mfma_f32_32x32x16_bf16 v[80:95], v[192:195], v[192:195], 0
v_mfma_f32_32x32x16_bf16 v[96:111], v[192:195], v[192:195], 0
v_mfma_f32_32x32x16_bf16 v[144:159], v[192:195], v[192:195], 0
v_mfma_f32_32x32x16_bf16 v[160:175], v[192:195], v[192:195], 0
v_mfma_f32_32x32x16_bf16 a[112:127], v[192:195], v[192:195], 0
v_mfma_f32_32x32x16_bf16 a[128:143], v[192:195], v[192:195], 0
v_mfma_f32_32x32x16_bf16 a[144:159], v[192:195], v[192:195], 0
v_mfma_f32_32x32x16_bf16 a[160:175], v[192:195], v[192:195], 0
v_mfma_f32_32x32x16_bf16 a[176:191], v[192:195], v[192:195], 0
v_mfma_f32_32x32x16_bf16 a[192:207], v[192:195], v[192:195], 0
v_mfma_f32_32x32x16_bf16 a[208:223], v[192:195], v[192:195], 0
v_mfma_f32_32x32x16_bf16 a[224:239], v[192:195], v[192:195], 0
v_mfma_f32_16x16x32_bf16 a[240:243], v[192:195], v[192:195], 0
v_mfma_f32_16x16x32_bf16 a[244:247], v[192:195], v[192:195], 0
v_mfma_f32_16x16x32_bf16 a[248:251], v[192:195], v[192:195], 0
s_nop 7
s_nop 3
s_branch L1_pass
.section .rodata,"a"
.p2align 6
.amdhsa_kernel concat_heads__gqa_block_cached__mha_block_cached__near_ridge_kernel
  .amdhsa_next_free_vgpr 512
  .amdhsa_next_free_sgpr 102
  .amdhsa_accum_offset 256
  .amdhsa_group_segment_fixed_size 0
  .amdhsa_kernarg_size 104
  .amdhsa_user_sgpr_count 2
  .amdhsa_user_sgpr_kernarg_segment_ptr 1
  .amdhsa_system_sgpr_workgroup_id_x 1
.end_amdhsa_kernel
```
